```python
import torch

def _softmax(x, axis=-1):
    return torch.softmax(x, dim=axis)

def _gelu(x):
    return torch.nn.functional.gelu(x, approximate='tanh')

def _silu(x):
    return torch.nn.functional.silu(x)

def _sigmoid(x):
    return torch.sigmoid(x)

def _layernorm(x, axis=-1, eps=1e-05):
    m = x.mean(dim=axis, keepdim=True)
    v = x.var(dim=axis, keepdim=True, unbiased=False)
    return (x - m) / torch.sqrt(v + eps)

def _scatter_add(tgt, idx, src, axis=0):
    return tgt.clone().index_add_(axis, idx, src)

def _segment_sum(src, seg, n):
    out = torch.zeros((n,) + src.shape[1:], dtype=src.dtype)
    return out.index_add_(0, seg, src)

def _pad(x, pw):
    flat = tuple((v for pair in reversed(pw) for v in pair))
    return torch.nn.functional.pad(x, flat)
kernel_name = 'adaLN_cond__spectral_fnet__mixer_gmlp__prompt'

def setup_inputs():

    _w = lambda a: (lambda t: t.to(torch.bfloat16) if t.is_floating_point() else t)(torch.as_tensor(a))

    def _A_setup():
        B, S, D = (1, 2048, 512)
        ns = torch.arange(S)[:, None] * torch.arange(S)[None, :]
        nd = torch.arange(D)[:, None] * torch.arange(D)[None, :]
        Ws_re = torch.cos(-2.0 * torch.pi * ns / S).to(float)
        Ws_im = torch.sin(-2.0 * torch.pi * ns / S).to(float)
        Wd_re = torch.cos(-2.0 * torch.pi * nd / D).to(float)
        Wd_im = torch.sin(-2.0 * torch.pi * nd / D).to(float)
        return {'x': _w((lambda *s: torch.randn(*s, dtype=torch.bfloat16) * 0.05)(B, S, D)), 'dft_seq_re': _w(Ws_re), 'dft_seq_im': _w(Ws_im), 'dft_hid_re': _w(Wd_re), 'dft_hid_im': _w(Wd_im)}
    _A_in = _A_setup()

    def _B_setup():
        B, S, D, F = (1, 2048, 512, 1792)
        Fh = F // 2
        return {'x': _w((lambda *s: torch.randn(*s, dtype=torch.bfloat16) * 0.05)(B, S, D)), 'w_in': _w((lambda *s: torch.randn(*s, dtype=torch.bfloat16) * 3.2)(D, 2 * Fh)), 'w_sp': _w(0.01 * (lambda *s: torch.randn(*s, dtype=torch.bfloat16) * 3.2)(S, S)), 'b_sp': _w(1.0 + 0.01 * (lambda *s: torch.randn(*s, dtype=torch.bfloat16) * 1.6)(S)), 'w_out': _w((lambda *s: torch.randn(*s, dtype=torch.bfloat16) * 1.6)(Fh, D))}
    _B_in = _B_setup()
    return {'A_x': _A_in['x'], 'A_dft_seq_re': _A_in['dft_seq_re'], 'A_dft_seq_im': _A_in['dft_seq_im'], 'A_dft_hid_re': _A_in['dft_hid_re'], 'A_dft_hid_im': _A_in['dft_hid_im'], 'B_x': _B_in['x'], 'B_w_in': _B_in['w_in'], 'B_w_sp': _B_in['w_sp'], 'B_b_sp': _B_in['b_sp'], 'B_w_out': _B_in['w_out'], 'c': _w((lambda *s: torch.randn(*s, dtype=torch.bfloat16) * 0.1)(1, 512) * 8.0), 'w_mod': _w((lambda *s: torch.randn(*s, dtype=torch.bfloat16) * 0.1)(512, 6 * 512) * 512 ** (-0.5) * 8.0)}

def reference(A_x, A_dft_seq_re, A_dft_seq_im, A_dft_hid_re, A_dft_hid_im, B_x, B_w_in, B_w_sp, B_b_sp, B_w_out, c, w_mod):

    def _A_ref(x, dft_seq_re, dft_seq_im, dft_hid_re, dft_hid_im):
        a = torch.einsum('bsd,ed->bse', x, dft_hid_re)
        b = torch.einsum('bsd,ed->bse', x, dft_hid_im)
        y = torch.einsum('ts,bse->bte', dft_seq_re, a) - torch.einsum('ts,bse->bte', dft_seq_im, b)
        return y

    def _B_ref(x, w_in, w_sp, b_sp, w_out):
        B, S, D = x.shape
        F = w_in.shape[-1]
        Fh = F // 2
        z = _gelu(torch.einsum('bsd,df->bsf', x, w_in))
        z1 = z[..., :Fh].clone()
        z2 = _layernorm(z[..., Fh:], axis=-1)
        g = torch.einsum('ts,bsf->btf', w_sp, z2) + b_sp[None, :, None]
        return torch.einsum('bsf,fd->bsd', z1 * g, w_out)
    x = A_x
    mod = (_silu(c) @ w_mod).reshape(c.shape[0], 6, 1, -1)
    sa, ca, ga, sb, cb, gb = (mod[:, 0].clone(), mod[:, 1].clone(), mod[:, 2].clone(), mod[:, 3].clone(), mod[:, 4].clone(), mod[:, 5].clone())
    h = _layernorm(x, axis=-1) * (1 + ca) + sa
    x = x + ga * _A_ref(h, A_dft_seq_re, A_dft_seq_im, A_dft_hid_re, A_dft_hid_im)
    h = _layernorm(x, axis=-1) * (1 + cb) + sb
    x = x + gb * _B_ref(h, B_w_in, B_w_sp, B_b_sp, B_w_out)
    return x
```

```asm
; @launch grid=(256,1,1) block=(512,1,1) lds=163840
.amdgcn_target "amdgcn-amd-amdhsa--gfx950"
.text
code_begin:
.globl adaLN_cond__spectral_fnet__mixer_gmlp__prompt_kernel
.p2align 8
.type adaLN_cond__spectral_fnet__mixer_gmlp__prompt_kernel,@function
adaLN_cond__spectral_fnet__mixer_gmlp__prompt_kernel:
    s_cmp_ge_u32 s2, 256
    s_cbranch_scc1 adaLN_cond__spectral_fnet__mixer_gmlp__prompt_kernel_end
    s_load_dwordx2 s[4:5], s[0:1], 112
    s_load_dwordx2 s[8:9], s[0:1], 48
    s_load_dwordx2 s[12:13], s[0:1], 56
    s_load_dwordx2 s[16:17], s[0:1], 72
    s_load_dwordx2 s[36:37], s[0:1], 64
    s_load_dwordx2 s[38:39], s[0:1], 96
    s_load_dwordx2 s[56:57], s[0:1], 0
    s_load_dwordx2 s[58:59], s[0:1], 88
    s_load_dwordx2 s[60:61], s[0:1], 80
    s_getpc_b64 s[62:63]
    s_add_u32 s62, s62, fft_tables@rel32@lo+4
    s_addc_u32 s63, s63, fft_tables@rel32@hi+12
    v_readfirstlane_b32 s20, v0
    s_lshr_b32 s20, s20, 6
    v_mov_b32 v1, 159744
    v_mov_b32 v4, 0
    v_mov_b32 v5, 0
    v_mov_b32 v6, 0
    v_mov_b32 v7, 0
    ds_write_b128 v1, v[4:7]
    s_waitcnt lgkmcnt(0)
    s_add_u32 s40, s4, 446464
    s_addc_u32 s41, s5, 0
    s_load_dword s64, s[40:41], 0
    s_cmp_ge_u32 s2, 128
    s_cbranch_scc1 adaLN_cond__spectral_fnet__mixer_gmlp__prompt_kernel_mod
    s_and_b32 s40, s2, 7
    s_bfe_u32 s41, s2, 0x20003
    s_lshl2_add_u32 s40, s40, s41
    s_lshl_b32 s40, s40, 10
    s_lshr_b32 s41, s2, 5
    v_lshrrev_b32 v4, 3, v0
    v_and_b32 v5, 7, v0
    v_lshlrev_b32 v4, 15, v4
    v_lshl_add_u32 v1, v5, 4, v4
    v_add_u32 v1, s40, v1
    v_lshlrev_b32 v10, 4, v0
    s_lshl_b32 s42, s20, 10
    s_add_u32 m0, s42, 16384
    global_load_dwordx4 v[12:15], v1, s[56:57] offset:0
    global_load_dwordx4 v[16:19], v1, s[56:57] offset:128
    global_load_dwordx4 v[20:23], v1, s[56:57] offset:256
    global_load_dwordx4 v[24:27], v1, s[56:57] offset:384
    global_load_dwordx4 v[28:31], v1, s[56:57] offset:512
    global_load_dwordx4 v[32:35], v1, s[56:57] offset:640
    global_load_dwordx4 v[36:39], v1, s[56:57] offset:768
    global_load_dwordx4 v[40:43], v1, s[56:57] offset:896
    global_load_lds_dwordx4 v10, s[62:63] offset:0
    v_and_b32 v2, 15, v0
    v_bfe_u32 v3, v0, 4, 2
    v_lshrrev_b32 v4, 8, v0
    v_bfe_u32 v5, v0, 6, 2
    s_lshl_b32 s42, s41, 8
    s_add_u32 s40, s40, s42
    s_add_u32 s40, s40, 4194304
    v_lshl_add_u32 v116, v4, 5, v2
    v_mul_u32_u24 v116, 272, v116
    v_lshl_add_u32 v116, v5, 5, v116
    v_lshl_add_u32 v116, v3, 3, v116
    v_add_u32 v116, 32768, v116
    v_lshrrev_b32 v118, 6, v0
    v_lshl_add_u32 v118, v118, 3, v3
    v_mul_u32_u24 v117, 272, v118
    v_lshl_add_u32 v117, v2, 4, v117
    v_add_u32 v117, 32768, v117
    v_lshlrev_b32 v118, 15, v118
    v_lshl_add_u32 v118, v2, 4, v118
    v_add_u32 v118, s40, v118
    v_lshlrev_b32 v8, 5, v5
    v_lshrrev_b32 v5, 2, v2
    v_lshl_add_u32 v5, v3, 3, v5
    v_lshl_add_u32 v8, v5, 7, v8
    v_and_b32 v5, 3, v2
    v_lshl_add_u32 v8, v5, 3, v8
    v_and_b32 v119, 63, v0
    v_lshlrev_b32 v119, 4, v119
    v_lshl_add_u32 v119, v4, 12, v119
    v_mov_b32 v6, 0
    v_mov_b32 v7, 0
    s_mov_b32 s42, 0x3f803f80
    s_waitcnt vmcnt(8)
    v_dot2_f32_bf16 v6, v12, s42, v6
    v_dot2_f32_bf16 v7, v12, v12, v7
    v_dot2_f32_bf16 v6, v13, s42, v6
    v_dot2_f32_bf16 v7, v13, v13, v7
    v_dot2_f32_bf16 v6, v14, s42, v6
    v_dot2_f32_bf16 v7, v14, v14, v7
    v_dot2_f32_bf16 v6, v15, s42, v6
    v_dot2_f32_bf16 v7, v15, v15, v7
    s_waitcnt vmcnt(7)
    v_dot2_f32_bf16 v6, v16, s42, v6
    v_dot2_f32_bf16 v7, v16, v16, v7
    v_dot2_f32_bf16 v6, v17, s42, v6
    v_dot2_f32_bf16 v7, v17, v17, v7
    v_dot2_f32_bf16 v6, v18, s42, v6
    v_dot2_f32_bf16 v7, v18, v18, v7
    v_dot2_f32_bf16 v6, v19, s42, v6
    v_dot2_f32_bf16 v7, v19, v19, v7
    s_waitcnt vmcnt(6)
    v_dot2_f32_bf16 v6, v20, s42, v6
    v_dot2_f32_bf16 v7, v20, v20, v7
    v_dot2_f32_bf16 v6, v21, s42, v6
    v_dot2_f32_bf16 v7, v21, v21, v7
    v_dot2_f32_bf16 v6, v22, s42, v6
    v_dot2_f32_bf16 v7, v22, v22, v7
    v_dot2_f32_bf16 v6, v23, s42, v6
    v_dot2_f32_bf16 v7, v23, v23, v7
    s_waitcnt vmcnt(5)
    v_dot2_f32_bf16 v6, v24, s42, v6
    v_dot2_f32_bf16 v7, v24, v24, v7
    v_dot2_f32_bf16 v6, v25, s42, v6
    v_dot2_f32_bf16 v7, v25, v25, v7
    v_dot2_f32_bf16 v6, v26, s42, v6
    v_dot2_f32_bf16 v7, v26, v26, v7
    v_dot2_f32_bf16 v6, v27, s42, v6
    v_dot2_f32_bf16 v7, v27, v27, v7
    s_waitcnt vmcnt(4)
    v_dot2_f32_bf16 v6, v28, s42, v6
    v_dot2_f32_bf16 v7, v28, v28, v7
    v_dot2_f32_bf16 v6, v29, s42, v6
    v_dot2_f32_bf16 v7, v29, v29, v7
    v_dot2_f32_bf16 v6, v30, s42, v6
    v_dot2_f32_bf16 v7, v30, v30, v7
    v_dot2_f32_bf16 v6, v31, s42, v6
    v_dot2_f32_bf16 v7, v31, v31, v7
    s_waitcnt vmcnt(3)
    v_dot2_f32_bf16 v6, v32, s42, v6
    v_dot2_f32_bf16 v7, v32, v32, v7
    v_dot2_f32_bf16 v6, v33, s42, v6
    v_dot2_f32_bf16 v7, v33, v33, v7
    v_dot2_f32_bf16 v6, v34, s42, v6
    v_dot2_f32_bf16 v7, v34, v34, v7
    v_dot2_f32_bf16 v6, v35, s42, v6
    v_dot2_f32_bf16 v7, v35, v35, v7
    s_waitcnt vmcnt(2)
    v_dot2_f32_bf16 v6, v36, s42, v6
    v_dot2_f32_bf16 v7, v36, v36, v7
    v_dot2_f32_bf16 v6, v37, s42, v6
    v_dot2_f32_bf16 v7, v37, v37, v7
    v_dot2_f32_bf16 v6, v38, s42, v6
    v_dot2_f32_bf16 v7, v38, v38, v7
    v_dot2_f32_bf16 v6, v39, s42, v6
    v_dot2_f32_bf16 v7, v39, v39, v7
    s_waitcnt vmcnt(1)
    v_dot2_f32_bf16 v6, v40, s42, v6
    v_dot2_f32_bf16 v7, v40, v40, v7
    v_dot2_f32_bf16 v6, v41, s42, v6
    v_dot2_f32_bf16 v7, v41, v41, v7
    v_dot2_f32_bf16 v6, v42, s42, v6
    v_dot2_f32_bf16 v7, v42, v42, v7
    v_dot2_f32_bf16 v6, v43, s42, v6
    v_dot2_f32_bf16 v7, v43, v43, v7
    s_lshl_b32 s43, s41, 3
    s_mov_b32 s42, 0xffff0000
    s_set_gpr_idx_on s43, gpr_idx(SRC0)
    v_mov_b32 v44, v12
    v_mov_b32 v45, v13
    v_mov_b32 v46, v14
    v_mov_b32 v47, v15
    v_mov_b32 v48, v16
    v_mov_b32 v49, v17
    v_mov_b32 v50, v18
    v_mov_b32 v51, v19
    s_set_gpr_idx_off
    v_add_f32_dpp v6, v6, v6 quad_perm:[1,0,3,2] row_mask:0xf bank_mask:0xf
    v_add_f32_dpp v7, v7, v7 quad_perm:[1,0,3,2] row_mask:0xf bank_mask:0xf
    v_lshlrev_b32 v100, 16, v44
    v_add_f32_dpp v6, v6, v6 quad_perm:[2,3,0,1] row_mask:0xf bank_mask:0xf
    v_add_f32_dpp v7, v7, v7 quad_perm:[2,3,0,1] row_mask:0xf bank_mask:0xf
    s_nop 0
    v_add_f32_dpp v6, v6, v6 row_half_mirror row_mask:0xf bank_mask:0xf
    v_add_f32_dpp v7, v7, v7 row_half_mirror row_mask:0xf bank_mask:0xf
    v_and_b32 v101, s42, v44
    v_lshlrev_b32 v102, 16, v45
    v_and_b32 v103, s42, v45
    v_lshlrev_b32 v104, 16, v46
    v_and_b32 v105, s42, v46
    v_lshlrev_b32 v106, 16, v47
    v_and_b32 v107, s42, v47
    v_lshlrev_b32 v108, 16, v48
    v_and_b32 v109, s42, v48
    v_lshlrev_b32 v110, 16, v49
    v_and_b32 v111, s42, v49
    v_lshlrev_b32 v112, 16, v50
    v_and_b32 v113, s42, v50
    v_lshlrev_b32 v114, 16, v51
    v_and_b32 v115, s42, v51
    v_mul_f32 v6, 0x3b000000, v6
    v_mul_f32 v7, 0x3b000000, v7
    v_fma_f32 v7, -v6, v6, v7
    v_max_f32 v7, 0, v7
    v_add_f32 v7, 0x3727c5ac, v7
    v_rsq_f32 v7, v7
    s_nop 0
    v_mul_f32 v6, v6, v7
    v_fma_f32 v100, v100, v7, -v6
    v_fma_f32 v101, v101, v7, -v6
    v_fma_f32 v102, v102, v7, -v6
    v_fma_f32 v103, v103, v7, -v6
    v_fma_f32 v104, v104, v7, -v6
    v_fma_f32 v105, v105, v7, -v6
    v_fma_f32 v106, v106, v7, -v6
    v_fma_f32 v107, v107, v7, -v6
    v_fma_f32 v108, v108, v7, -v6
    v_fma_f32 v109, v109, v7, -v6
    v_fma_f32 v110, v110, v7, -v6
    v_fma_f32 v111, v111, v7, -v6
    v_fma_f32 v112, v112, v7, -v6
    v_fma_f32 v113, v113, v7, -v6
    v_fma_f32 v114, v114, v7, -v6
    v_fma_f32 v115, v115, v7, -v6
    v_cvt_pk_bf16_f32 v44, v100, v101
    v_cvt_pk_bf16_f32 v45, v102, v103
    v_cvt_pk_bf16_f32 v46, v104, v105
    v_cvt_pk_bf16_f32 v47, v106, v107
    ds_write_b128 v10, v[44:47] offset:0
    v_cvt_pk_bf16_f32 v48, v108, v109
    v_cvt_pk_bf16_f32 v49, v110, v111
    v_cvt_pk_bf16_f32 v50, v112, v113
    v_cvt_pk_bf16_f32 v51, v114, v115
    ds_write_b128 v10, v[48:51] offset:8192
    s_waitcnt vmcnt(0) lgkmcnt(0)
    s_barrier
    ds_read_b64_tr_b16 v[68:69], v8 offset:0
    ds_read_b64_tr_b16 v[70:71], v8 offset:512
    ds_read_b64_tr_b16 v[72:73], v8 offset:4096
    ds_read_b64_tr_b16 v[74:75], v8 offset:4608
    ds_read_b128 v[52:55], v119 offset:16384
    ds_read_b128 v[56:59], v119 offset:17408
    ds_read_b128 v[60:63], v119 offset:18432
    ds_read_b128 v[64:67], v119 offset:19456
    ds_read_b64_tr_b16 v[76:77], v8 offset:8192
    ds_read_b64_tr_b16 v[78:79], v8 offset:8704
    ds_read_b64_tr_b16 v[80:81], v8 offset:12288
    ds_read_b64_tr_b16 v[82:83], v8 offset:12800
    s_waitcnt lgkmcnt(4)
    v_mfma_f32_16x16x32_bf16 v[84:87], v[68:71], v[52:55], 0
    v_mfma_f32_16x16x32_bf16 v[88:91], v[68:71], v[60:63], 0
    v_mfma_f32_16x16x32_bf16 v[84:87], v[72:75], v[56:59], v[84:87]
    v_mfma_f32_16x16x32_bf16 v[88:91], v[72:75], v[64:67], v[88:91]
    s_waitcnt lgkmcnt(0)
    v_mfma_f32_16x16x32_bf16 v[92:95], v[76:79], v[52:55], 0
    v_mfma_f32_16x16x32_bf16 v[96:99], v[76:79], v[60:63], 0
    v_mfma_f32_16x16x32_bf16 v[92:95], v[80:83], v[56:59], v[92:95]
    v_mfma_f32_16x16x32_bf16 v[96:99], v[80:83], v[64:67], v[96:99]
    s_nop 1
    v_cvt_pk_bf16_f32 v100, v84, v85
    v_cvt_pk_bf16_f32 v101, v86, v87
    ds_write_b64 v116, v[100:101] offset:0
    v_cvt_pk_bf16_f32 v102, v88, v89
    v_cvt_pk_bf16_f32 v103, v90, v91
    ds_write_b64 v116, v[102:103] offset:4352
    v_cvt_pk_bf16_f32 v104, v92, v93
    v_cvt_pk_bf16_f32 v105, v94, v95
    ds_write_b64 v116, v[104:105] offset:128
    v_cvt_pk_bf16_f32 v106, v96, v97
    v_cvt_pk_bf16_f32 v107, v98, v99
    ds_write_b64 v116, v[106:107] offset:4480
    s_waitcnt lgkmcnt(0)
    s_barrier
    ds_read_b128 v[108:111], v117 offset:0
    ds_read_b128 v[112:115], v117 offset:1088
    s_waitcnt lgkmcnt(1)
    global_store_dwordx4 v118, v[108:111], s[4:5] sc1
    v_add_u32 v118, 131072, v118
    s_waitcnt lgkmcnt(0)
    global_store_dwordx4 v118, v[112:115], s[4:5] sc1
    s_waitcnt lgkmcnt(0)
    s_add_u32 s64, s64, 1
    s_lshl_b32 s23, s2, 7
    s_add_u32 s23, s23, 327680
    v_mov_b32 v250, 159752
    v_mov_b32 v251, 1
    s_waitcnt vmcnt(0)
    s_mov_b64 exec, 1
    ds_add_rtn_u32 v250, v250, v251
    s_waitcnt lgkmcnt(0)
    v_readfirstlane_b32 s24, v250
    v_mov_b32 v250, s23
    v_mov_b32 v251, s64
    s_cmp_lg_u32 s24, 7
    s_cbranch_scc1 adaLN_cond__spectral_fnet__mixer_gmlp__prompt_kernel_noflaf
    global_store_dword v250, v251, s[4:5] sc1
adaLN_cond__spectral_fnet__mixer_gmlp__prompt_kernel_noflaf:
    s_mov_b64 exec, -1
    s_branch adaLN_cond__spectral_fnet__mixer_gmlp__prompt_kernel_adone
adaLN_cond__spectral_fnet__mixer_gmlp__prompt_kernel_mod:
    s_cmp_ge_u32 s2, 224
    s_cbranch_scc1 adaLN_cond__spectral_fnet__mixer_gmlp__prompt_kernel_pf
    s_sub_u32 s40, s2, 128
    s_lshl_b32 s41, s40, 6
    v_and_b32 v2, 0x1c0, v0
    v_bfe_u32 v3, v0, 2, 4
    v_add_u32 v1, v2, v3
    v_and_b32 v4, 3, v0
    v_mul_u32_u24 v5, 6144, v1
    v_lshl_add_u32 v5, v4, 4, v5
    v_add_u32 v5, s41, v5
    v_add_u32 v6, 98304, v5
    v_add_u32 v7, 196608, v5
    v_add_u32 v8, 294912, v5
    v_lshlrev_b32 v1, 1, v1
    global_load_ushort v28, v1, s[60:61] offset:0
    global_load_ushort v29, v1, s[60:61] offset:32
    global_load_ushort v30, v1, s[60:61] offset:64
    global_load_ushort v31, v1, s[60:61] offset:96
    global_load_dwordx4 v[12:15], v5, s[58:59]
    global_load_dwordx4 v[16:19], v6, s[58:59]
    global_load_dwordx4 v[20:23], v7, s[58:59]
    global_load_dwordx4 v[24:27], v8, s[58:59]
    v_mov_b32 v36, 0
    v_mov_b32 v37, 0
    v_mov_b32 v38, 0
    v_mov_b32 v39, 0
    v_mov_b32 v40, 0
    v_mov_b32 v41, 0
    v_mov_b32 v42, 0
    v_mov_b32 v43, 0
    s_waitcnt vmcnt(4)
    v_lshlrev_b32 v28, 16, v28
    v_lshlrev_b32 v29, 16, v29
    v_lshlrev_b32 v30, 16, v30
    v_lshlrev_b32 v31, 16, v31
    v_mul_f32 v32, 0xbfb8aa3b, v28
    v_mul_f32 v33, 0xbfb8aa3b, v29
    v_mul_f32 v34, 0xbfb8aa3b, v30
    v_mul_f32 v35, 0xbfb8aa3b, v31
    v_exp_f32 v32, v32
    v_exp_f32 v33, v33
    v_exp_f32 v34, v34
    v_exp_f32 v35, v35
    v_add_f32 v32, 1.0, v32
    v_add_f32 v33, 1.0, v33
    v_add_f32 v34, 1.0, v34
    v_add_f32 v35, 1.0, v35
    v_rcp_f32 v32, v32
    v_rcp_f32 v33, v33
    v_rcp_f32 v34, v34
    v_rcp_f32 v35, v35
    v_mul_f32 v28, v28, v32
    v_mul_f32 v29, v29, v33
    v_mul_f32 v30, v30, v34
    v_mul_f32 v31, v31, v35
    v_cvt_pk_bf16_f32 v28, v28, 0
    v_cvt_pk_bf16_f32 v29, v29, 0
    v_cvt_pk_bf16_f32 v30, v30, 0
    v_cvt_pk_bf16_f32 v31, v31, 0
    v_lshlrev_b32 v32, 16, v28
    v_lshlrev_b32 v33, 16, v29
    v_lshlrev_b32 v34, 16, v30
    v_lshlrev_b32 v35, 16, v31
    s_waitcnt vmcnt(3)
    v_dot2_f32_bf16 v36, v12, v28, v36
    v_dot2_f32_bf16 v37, v12, v32, v37
    v_dot2_f32_bf16 v38, v13, v28, v38
    v_dot2_f32_bf16 v39, v13, v32, v39
    v_dot2_f32_bf16 v40, v14, v28, v40
    v_dot2_f32_bf16 v41, v14, v32, v41
    v_dot2_f32_bf16 v42, v15, v28, v42
    v_dot2_f32_bf16 v43, v15, v32, v43
    s_waitcnt vmcnt(2)
    v_dot2_f32_bf16 v36, v16, v29, v36
    v_dot2_f32_bf16 v37, v16, v33, v37
    v_dot2_f32_bf16 v38, v17, v29, v38
    v_dot2_f32_bf16 v39, v17, v33, v39
    v_dot2_f32_bf16 v40, v18, v29, v40
    v_dot2_f32_bf16 v41, v18, v33, v41
    v_dot2_f32_bf16 v42, v19, v29, v42
    v_dot2_f32_bf16 v43, v19, v33, v43
    s_waitcnt vmcnt(1)
    v_dot2_f32_bf16 v36, v20, v30, v36
    v_dot2_f32_bf16 v37, v20, v34, v37
    v_dot2_f32_bf16 v38, v21, v30, v38
    v_dot2_f32_bf16 v39, v21, v34, v39
    v_dot2_f32_bf16 v40, v22, v30, v40
    v_dot2_f32_bf16 v41, v22, v34, v41
    v_dot2_f32_bf16 v42, v23, v30, v42
    v_dot2_f32_bf16 v43, v23, v34, v43
    s_waitcnt vmcnt(0)
    v_dot2_f32_bf16 v36, v24, v31, v36
    v_dot2_f32_bf16 v37, v24, v35, v37
    v_dot2_f32_bf16 v38, v25, v31, v38
    v_dot2_f32_bf16 v39, v25, v35, v39
    v_dot2_f32_bf16 v40, v26, v31, v40
    v_dot2_f32_bf16 v41, v26, v35, v41
    v_dot2_f32_bf16 v42, v27, v31, v42
    v_dot2_f32_bf16 v43, v27, v35, v43
    v_add_f32_dpp v36, v36, v36 row_ror:4 row_mask:0xf bank_mask:0xf
    v_add_f32_dpp v37, v37, v37 row_ror:4 row_mask:0xf bank_mask:0xf
    v_add_f32_dpp v38, v38, v38 row_ror:4 row_mask:0xf bank_mask:0xf
    v_add_f32_dpp v39, v39, v39 row_ror:4 row_mask:0xf bank_mask:0xf
    v_add_f32_dpp v40, v40, v40 row_ror:4 row_mask:0xf bank_mask:0xf
    v_add_f32_dpp v41, v41, v41 row_ror:4 row_mask:0xf bank_mask:0xf
    v_add_f32_dpp v42, v42, v42 row_ror:4 row_mask:0xf bank_mask:0xf
    v_add_f32_dpp v43, v43, v43 row_ror:4 row_mask:0xf bank_mask:0xf
    v_add_f32_dpp v36, v36, v36 row_ror:8 row_mask:0xf bank_mask:0xf
    v_add_f32_dpp v37, v37, v37 row_ror:8 row_mask:0xf bank_mask:0xf
    v_add_f32_dpp v38, v38, v38 row_ror:8 row_mask:0xf bank_mask:0xf
    v_add_f32_dpp v39, v39, v39 row_ror:8 row_mask:0xf bank_mask:0xf
    v_add_f32_dpp v40, v40, v40 row_ror:8 row_mask:0xf bank_mask:0xf
    v_add_f32_dpp v41, v41, v41 row_ror:8 row_mask:0xf bank_mask:0xf
    v_add_f32_dpp v42, v42, v42 row_ror:8 row_mask:0xf bank_mask:0xf
    v_add_f32_dpp v43, v43, v43 row_ror:8 row_mask:0xf bank_mask:0xf
    v_lshrrev_b32 v2, 4, v0
    v_lshlrev_b32 v2, 7, v2
    v_lshl_add_u32 v2, v4, 5, v2
    ds_write_b128 v2, v[36:39]
    ds_write_b128 v2, v[40:43] offset:16
    s_cmp_ge_u32 s40, 8
    s_cbranch_scc1 adaLN_cond__spectral_fnet__mixer_gmlp__prompt_kernel_nocp
    s_getpc_b64 s[44:45]
    s_add_u32 s44, s44, code_begin@rel32@lo+4
    s_addc_u32 s45, s45, code_begin@rel32@hi+12
    v_lshlrev_b32 v2, 7, v0
    v_mov_b32 v3, code_end-code_begin-4
    v_min_u32 v2, v2, v3
    v_and_b32 v2, -4, v2
    global_load_dword v1, v2, s[44:45]
adaLN_cond__spectral_fnet__mixer_gmlp__prompt_kernel_nocp:
    s_waitcnt lgkmcnt(0)
    s_barrier
    s_cmp_ge_u32 s20, 1
    s_cbranch_scc1 adaLN_cond__spectral_fnet__mixer_gmlp__prompt_kernel_aend
    v_and_b32 v3, 31, v0
    v_lshrrev_b32 v2, 5, v0
    v_lshlrev_b32 v2, 11, v2
    v_lshl_add_u32 v2, v3, 2, v2
    ds_read_b32 v44, v2 offset:0
    ds_read_b32 v45, v2 offset:128
    ds_read_b32 v46, v2 offset:256
    ds_read_b32 v47, v2 offset:384
    ds_read_b32 v48, v2 offset:512
    ds_read_b32 v49, v2 offset:640
    ds_read_b32 v50, v2 offset:768
    ds_read_b32 v51, v2 offset:896
    ds_read_b32 v52, v2 offset:1024
    ds_read_b32 v53, v2 offset:1152
    ds_read_b32 v54, v2 offset:1280
    ds_read_b32 v55, v2 offset:1408
    ds_read_b32 v56, v2 offset:1536
    ds_read_b32 v57, v2 offset:1664
    ds_read_b32 v58, v2 offset:1792
    ds_read_b32 v59, v2 offset:1920
    s_lshr_b32 s41, s40, 4
    s_cmp_eq_u32 s41, 1
    s_cselect_b32 s42, 1.0, 0
    s_cmp_eq_u32 s41, 4
    s_cselect_b32 s42, 1.0, s42
    s_lshl_b32 s41, s40, 7
    v_lshl_add_u32 v3, v3, 2, s41
    s_waitcnt lgkmcnt(0)
    v_add_f32 v44, v44, v52
    v_add_f32 v45, v45, v53
    v_add_f32 v46, v46, v54
    v_add_f32 v47, v47, v55
    v_add_f32 v48, v48, v56
    v_add_f32 v49, v49, v57
    v_add_f32 v50, v50, v58
    v_add_f32 v51, v51, v59
    v_add_f32 v44, v44, v48
    v_add_f32 v45, v45, v49
    v_add_f32 v46, v46, v50
    v_add_f32 v47, v47, v51
    v_add_f32 v44, v44, v46
    v_add_f32 v45, v45, v47
    v_add_f32 v44, v44, v45
    v_mov_b32 v45, v44
    s_nop 1
    v_permlane32_swap_b32 v44, v45
    v_add_f32 v44, v44, v45
    v_cvt_pk_bf16_f32 v44, v44, v44
    v_lshlrev_b32 v44, 16, v44
    v_add_f32 v44, s42, v44
    v_cvt_pk_bf16_f32 v44, v44, v44
    v_lshlrev_b32 v44, 16, v44
    global_store_dword v3, v44, s[4:5] sc1
adaLN_cond__spectral_fnet__mixer_gmlp__prompt_kernel_aend:
    s_waitcnt lgkmcnt(0)
    s_add_u32 s64, s64, 1
    s_lshl_b32 s23, s2, 7
    s_add_u32 s23, s23, 327680
    v_mov_b32 v250, 159752
    v_mov_b32 v251, 1
    s_waitcnt vmcnt(0)
    s_mov_b64 exec, 1
    ds_add_rtn_u32 v250, v250, v251
    s_waitcnt lgkmcnt(0)
    v_readfirstlane_b32 s24, v250
    v_mov_b32 v250, s23
    v_mov_b32 v251, s64
    s_cmp_lg_u32 s24, 7
    s_cbranch_scc1 adaLN_cond__spectral_fnet__mixer_gmlp__prompt_kernel_noflam
    global_store_dword v250, v251, s[4:5] sc1
adaLN_cond__spectral_fnet__mixer_gmlp__prompt_kernel_noflam:
    s_mov_b64 exec, -1
    s_branch adaLN_cond__spectral_fnet__mixer_gmlp__prompt_kernel_adone
adaLN_cond__spectral_fnet__mixer_gmlp__prompt_kernel_pf:
    s_sub_u32 s40, s2, 224
    s_lshl_b32 s41, s40, 13
    s_add_u32 s41, s41, 65536
    v_lshl_add_u32 v1, v0, 4, s41
    v_mov_b32 v4, -1
    v_mov_b32 v5, -1
    v_mov_b32 v6, -1
    v_mov_b32 v7, -1
    global_store_dwordx4 v1, v[4:7], s[4:5] sc1
    s_barrier
    s_waitcnt lgkmcnt(0)
    s_add_u32 s64, s64, 1
    s_lshl_b32 s23, s2, 7
    s_add_u32 s23, s23, 327680
    v_mov_b32 v250, 159752
    v_mov_b32 v251, 1
    s_waitcnt vmcnt(0)
    s_mov_b64 exec, 1
    ds_add_rtn_u32 v250, v250, v251
    s_waitcnt lgkmcnt(0)
    v_readfirstlane_b32 s24, v250
    v_mov_b32 v250, s23
    v_mov_b32 v251, s64
    s_cmp_lg_u32 s24, 7
    s_cbranch_scc1 adaLN_cond__spectral_fnet__mixer_gmlp__prompt_kernel_noflap
    global_store_dword v250, v251, s[4:5] sc1
adaLN_cond__spectral_fnet__mixer_gmlp__prompt_kernel_noflap:
    s_mov_b64 exec, -1
    s_mul_i32 s40, s40, 448
    v_add_u32 v1, s40, v0
    v_lshlrev_b32 v1, 7, v1
    v_cmp_gt_u32 vcc, 448, v0
    s_and_saveexec_b64 s[42:43], vcc
    s_cbranch_execz adaLN_cond__spectral_fnet__mixer_gmlp__prompt_kernel_pfx
    global_load_dword v252, v1, s[8:9]
adaLN_cond__spectral_fnet__mixer_gmlp__prompt_kernel_pfx:
    s_mov_b64 exec, s[42:43]
adaLN_cond__spectral_fnet__mixer_gmlp__prompt_kernel_adone:
    s_barrier
    s_cmp_ge_u32 s2, 132
    s_cbranch_scc1 adaLN_cond__spectral_fnet__mixer_gmlp__prompt_kernel_bdone
    s_mov_b32 s6, 6291456
    s_mov_b32 s7, 0x20000
    s_and_b32 s23, s2, 7
    s_bfe_u32 s22, s2, 0x20003
    s_lshr_b32 s24, s2, 5
    s_lshl3_add_u32 s21, s24, s23
    s_cmp_ge_u32 s2, 128
    s_cselect_b32 s21, 32, s21
    s_cselect_b32 s22, s23, s22
    v_and_b32 v1, 63, v0
    v_lshlrev_b32 v4, 4, v1
    v_lshlrev_b32 v5, 4, v0
    v_and_b32 v3, 15, v0
    v_bfe_u32 v2, v0, 4, 2
    s_lshl3_add_u32 s24, s22, s20
    s_lshl_b32 s24, s24, 6
    s_add_u32 s26, s24, s21
    s_sub_u32 s29, 2048, s26
    s_and_b32 s29, s29, 2047
    s_lshl_b32 s26, s26, 10
    s_lshl_b32 s29, s29, 10
    v_add_u32 v154, s26, v4
    v_add_u32 v155, s29, v4
    s_lshl_b32 s25, s20, 10
    s_add_u32 m0, s25, 0
    v_add_u32 v9, 8192, v5
    global_load_lds_dwordx4 v9, s[62:63]
    s_cmp_ge_u32 s20, 2
    s_cbranch_scc1 adaLN_cond__spectral_fnet__mixer_gmlp__prompt_kernel_bnox
    s_add_u32 m0, s25, 8192
    v_add_u32 v9, 8192, v9
    global_load_lds_dwordx4 v9, s[62:63]
adaLN_cond__spectral_fnet__mixer_gmlp__prompt_kernel_bnox:
    global_load_dwordx4 v[68:71], v154, s[56:57]
    global_load_dwordx4 v[72:75], v155, s[56:57]
    v_lshrrev_b32 v8, 2, v3
    v_lshl_add_u32 v8, v2, 2, v8
    v_mul_u32_u24 v148, 1056, v8
    v_and_b32 v8, 3, v3
    v_lshl_add_u32 v148, v8, 3, v148
    v_and_b32 v12, 0x1c0, v0
    v_lshl_add_u32 v148, v12, 1, v148
    v_add_u32 v148, 19456, v148
    v_lshl_add_u32 v8, v2, 6, v3
    v_mul_u32_u24 v149, 80, v8
    v_lshrrev_b32 v8, 3, v12
    s_mov_b32 s25, 87040
    v_add3_u32 v149, v149, v8, s25
    v_lshrrev_b32 v8, 1, v12
    v_add_u32 v8, v8, v3
    v_mul_u32_u24 v150, 80, v8
    v_lshl_add_u32 v150, v2, 4, v150
    v_add_u32 v150, 87040, v150
    v_lshrrev_b32 v8, 2, v12
    v_lshl_add_u32 v11, v2, 1, v8
    v_mul_u32_u24 v151, 144, v11
    v_lshl_add_u32 v151, v3, 2, v151
    v_add_u32 v11, v8, v3
    v_mul_u32_u24 v152, 144, v11
    v_lshl_add_u32 v152, v2, 4, v152
    s_mul_i32 s49, s20, 2064
    s_add_u32 s49, s49, 39936
    v_lshlrev_b32 v153, 6, v3
    v_lshl_add_u32 v153, v2, 4, v153
    v_add_u32 v153, s49, v153
    v_lshrrev_b32 v13, 1, v3
    v_lshlrev_b32 v13, 6, v13
    v_lshl_add_u32 v13, v2, 3, v13
    v_add_u32 v14, v12, v3
    v_lshlrev_b32 v14, 2, v14
    v_and_b32 v11, 1, v0
    v_cmp_eq_u32 vcc, 1, v11
    s_lshl_b32 s24, s22, 9
    s_add_u32 s24, s24, s21
    v_lshrrev_b32 v172, 1, v3
    v_lshl_add_u32 v172, v172, 6, s24
    v_lshlrev_b32 v173, 2, v2
    v_mul_u32_u24 v173, v172, v173
    v_mad_u32_u24 v176, v172, 0, v173
    v_and_b32 v176, 2047, v176
    v_cvt_f32_u32 v176, v176
    v_mul_f32 v176, 0x3a000000, v176
    v_mad_u32_u24 v177, v172, 1, v173
    v_and_b32 v177, 2047, v177
    v_cvt_f32_u32 v177, v177
    v_mul_f32 v177, 0x3a000000, v177
    v_sin_f32 v178, v176
    v_cos_f32 v176, v176
    v_sin_f32 v179, v177
    v_cos_f32 v177, v177
    v_sub_f32 v8, 0, v178
    v_sub_f32 v9, 0, v179
    v_cndmask_b32 v8, v176, v8, vcc
    v_cndmask_b32 v9, v177, v9, vcc
    v_cvt_pk_bf16_f32 v16, v8, v9
    v_cndmask_b32 v10, v178, v176, vcc
    v_cndmask_b32 v15, v179, v177, vcc
    v_cvt_pk_bf16_f32 v20, v10, v15
    v_mad_u32_u24 v176, v172, 2, v173
    v_and_b32 v176, 2047, v176
    v_cvt_f32_u32 v176, v176
    v_mul_f32 v176, 0x3a000000, v176
    v_mad_u32_u24 v177, v172, 3, v173
    v_and_b32 v177, 2047, v177
    v_cvt_f32_u32 v177, v177
    v_mul_f32 v177, 0x3a000000, v177
    v_sin_f32 v178, v176
    v_cos_f32 v176, v176
    v_sin_f32 v179, v177
    v_cos_f32 v177, v177
    v_sub_f32 v8, 0, v178
    v_sub_f32 v9, 0, v179
    v_cndmask_b32 v8, v176, v8, vcc
    v_cndmask_b32 v9, v177, v9, vcc
    v_cvt_pk_bf16_f32 v17, v8, v9
    v_cndmask_b32 v10, v178, v176, vcc
    v_cndmask_b32 v15, v179, v177, vcc
    v_cvt_pk_bf16_f32 v21, v10, v15
    v_mad_u32_u24 v176, v172, 16, v173
    v_and_b32 v176, 2047, v176
    v_cvt_f32_u32 v176, v176
    v_mul_f32 v176, 0x3a000000, v176
    v_mad_u32_u24 v177, v172, 17, v173
    v_and_b32 v177, 2047, v177
    v_cvt_f32_u32 v177, v177
    v_mul_f32 v177, 0x3a000000, v177
    v_sin_f32 v178, v176
    v_cos_f32 v176, v176
    v_sin_f32 v179, v177
    v_cos_f32 v177, v177
    v_sub_f32 v8, 0, v178
    v_sub_f32 v9, 0, v179
    v_cndmask_b32 v8, v176, v8, vcc
    v_cndmask_b32 v9, v177, v9, vcc
    v_cvt_pk_bf16_f32 v18, v8, v9
    v_cndmask_b32 v10, v178, v176, vcc
    v_cndmask_b32 v15, v179, v177, vcc
    v_cvt_pk_bf16_f32 v22, v10, v15
    v_mad_u32_u24 v176, v172, 18, v173
    v_and_b32 v176, 2047, v176
    v_cvt_f32_u32 v176, v176
    v_mul_f32 v176, 0x3a000000, v176
    v_mad_u32_u24 v177, v172, 19, v173
    v_and_b32 v177, 2047, v177
    v_cvt_f32_u32 v177, v177
    v_mul_f32 v177, 0x3a000000, v177
    v_sin_f32 v178, v176
    v_cos_f32 v176, v176
    v_sin_f32 v179, v177
    v_cos_f32 v177, v177
    v_sub_f32 v8, 0, v178
    v_sub_f32 v9, 0, v179
    v_cndmask_b32 v8, v176, v8, vcc
    v_cndmask_b32 v9, v177, v9, vcc
    v_cvt_pk_bf16_f32 v19, v8, v9
    v_cndmask_b32 v10, v178, v176, vcc
    v_cndmask_b32 v15, v179, v177, vcc
    v_cvt_pk_bf16_f32 v23, v10, v15
    s_add_u32 s24, s21, 32
    s_and_b32 s25, s21, 31
    s_cselect_b32 s27, 1, 0
    s_cselect_b32 s24, s24, 0x4000
    s_cmp_ge_u32 s20, 4
    s_cselect_b32 s23, s24, s21
    s_lshl_b32 s23, s23, 15
    s_and_b32 s24, s20, 3
    s_lshl_b32 s24, s24, 13
    s_add_u32 s23, s23, s24
    s_add_u32 s23, s23, 4194176
    s_mul_i32 s24, s20, 8448
    s_add_u32 m0, s24, 19456
    v_add_u32 v12, 128, v4
    v_add_u32 v13, 96, v4
    v_add_u32 v14, 64, v4
    v_add_u32 v15, 32, v4
    s_lshl_b32 s25, s20, 10
    s_mov_b32 s48, 327680
    s_cmp_lg_u32 s20, 0
    s_cbranch_scc1 adaLN_cond__spectral_fnet__mixer_gmlp__prompt_kernel_da
    v_and_b32 v244, 63, v0
    v_lshl_add_u32 v244, v244, 7, s48
    v_add_u32 v245, 8192, v244
    v_add_u32 v246, 16384, v244
    v_add_u32 v247, 24576, v244
    s_mov_b32 s28, 0
adaLN_cond__spectral_fnet__mixer_gmlp__prompt_kernel_wa:
    global_load_dword v248, v244, s[4:5] sc1
    global_load_dword v249, v245, s[4:5] sc1
    global_load_dword v250, v246, s[4:5] sc1
    global_load_dword v251, v247, s[4:5] sc1
    s_waitcnt vmcnt(0)
    v_xor_b32 v248, s64, v248
    v_xor_b32 v249, s64, v249
    v_xor_b32 v250, s64, v250
    v_xor_b32 v251, s64, v251
    v_or_b32 v248, v248, v249
    v_or_b32 v248, v248, v250
    v_or_b32 v248, v248, v251
    v_cmp_ne_u32 vcc, 0, v248
    s_add_u32 s28, s28, 1
    s_cmp_eq_u64 vcc, 0
    s_cbranch_scc1 adaLN_cond__spectral_fnet__mixer_gmlp__prompt_kernel_da
    s_sleep 1
    s_cmp_lt_u32 s28, 262144
    s_cbranch_scc1 adaLN_cond__spectral_fnet__mixer_gmlp__prompt_kernel_wa
adaLN_cond__spectral_fnet__mixer_gmlp__prompt_kernel_da:
    s_barrier
    buffer_load_dwordx4 v12, s[4:7], s23 offen offset:0 sc1 lds
    buffer_load_dwordx4 v13, s[4:7], s23 offen offset:1056 sc1 lds
    buffer_load_dwordx4 v14, s[4:7], s23 offen offset:2112 sc1 lds
    buffer_load_dwordx4 v15, s[4:7], s23 offen offset:3168 sc1 lds
    s_add_u32 m0, m0, 4224
    s_add_u32 s23, s23, 4096
    buffer_load_dwordx4 v12, s[4:7], s23 offen offset:0 sc1 lds
    buffer_load_dwordx4 v13, s[4:7], s23 offen offset:1056 sc1 lds
    buffer_load_dwordx4 v14, s[4:7], s23 offen offset:2112 sc1 lds
    buffer_load_dwordx4 v15, s[4:7], s23 offen offset:3168 sc1 lds
    s_add_u32 m0, s25, 10240
    v_add_u32 v10, 2048, v5
    global_load_lds_dwordx4 v10, s[4:5] sc1
    s_waitcnt vmcnt(0)
    v_and_b32 v12, 0x1c0, v0
    v_add_u32 v14, v12, v3
    v_lshlrev_b32 v14, 2, v14
    s_lshr_b32 s25, s2, 3
    s_lshl3_add_u32 s25, s25, s20
    s_and_b32 s25, s25, 127
    s_mul_i32 s25, s25, 56
    v_min_u32 v180, 55, v1
    v_add_u32 v180, s25, v180
    v_mul_u32_u24 v182, 9363, v180
    v_lshrrev_b32 v182, 17, v182
    v_mul_u32_u24 v183, 14, v182
    v_sub_u32 v183, v180, v183
    v_mul_u32_u24 v180, 3584, v182
    v_lshl_add_u32 v180, v183, 7, v180
    v_cmp_lt_u32 s[46:47], 6, v183
    v_mov_b32 v182, 896
    s_nop 0
    v_cndmask_b32 v182, 0, v182, s[46:47]
    s_and_b32 s24, s2, 1
    s_mul_i32 s24, s24, 896
    v_add3_u32 v180, v180, v182, s24
    s_barrier
    global_load_dword v182, v180, s[8:9]
    ds_read_b64_tr_b16 v[76:77], v148 offset:0
    ds_read_b64_tr_b16 v[78:79], v148 offset:16896
    ds_read_b64_tr_b16 v[80:81], v148 offset:33792
    ds_read_b64_tr_b16 v[82:83], v148 offset:50688
    ds_read_b64_tr_b16 v[84:85], v148 offset:32
    ds_read_b64_tr_b16 v[86:87], v148 offset:16928
    ds_read_b64_tr_b16 v[88:89], v148 offset:33824
    ds_read_b64_tr_b16 v[90:91], v148 offset:50720
    ds_read_b64_tr_b16 v[92:93], v148 offset:64
    ds_read_b64_tr_b16 v[94:95], v148 offset:16960
    ds_read_b64_tr_b16 v[96:97], v148 offset:33856
    ds_read_b64_tr_b16 v[98:99], v148 offset:50752
    ds_read_b64_tr_b16 v[100:101], v148 offset:96
    ds_read_b64_tr_b16 v[102:103], v148 offset:16992
    ds_read_b64_tr_b16 v[104:105], v148 offset:33888
    ds_read_b64_tr_b16 v[106:107], v148 offset:50784
    ds_read_b32 v64, v14 offset:10240
    ds_read_b32 v65, v14 offset:10304
    ds_read_b32 v66, v14 offset:10368
    ds_read_b32 v67, v14 offset:10432
    s_waitcnt lgkmcnt(15)
    v_mfma_f32_16x16x32_bf16 v[108:111], v[16:19], v[76:79], 0
    v_mfma_f32_16x16x32_bf16 v[108:111], v[20:23], v[80:83], v[108:111]
    s_waitcnt lgkmcnt(12)
    v_mfma_f32_16x16x32_bf16 v[112:115], v[16:19], v[84:87], 0
    v_mfma_f32_16x16x32_bf16 v[112:115], v[20:23], v[88:91], v[112:115]
    s_waitcnt lgkmcnt(8)
    v_mfma_f32_16x16x32_bf16 v[116:119], v[16:19], v[92:95], 0
    v_mfma_f32_16x16x32_bf16 v[116:119], v[20:23], v[96:99], v[116:119]
    s_waitcnt lgkmcnt(4)
    v_mfma_f32_16x16x32_bf16 v[120:123], v[16:19], v[100:103], 0
    v_mfma_f32_16x16x32_bf16 v[120:123], v[20:23], v[104:107], v[120:123]
    ds_read_b128 v[24:27], v4 offset:0
    ds_read_b128 v[28:31], v4 offset:1024
    v_lshlrev_b32 v15, 2, v4
    ds_read_b128 v[48:51], v15 offset:6144
    ds_read_b128 v[52:55], v15 offset:6160
    ds_read_b128 v[56:59], v15 offset:6176
    ds_read_b128 v[60:63], v15 offset:6192
    s_waitcnt lgkmcnt(6)
    v_mul_f32 v108, v108, v64
    v_mul_f32 v109, v109, v64
    v_mul_f32 v110, v110, v64
    v_mul_f32 v111, v111, v64
    v_mul_f32 v112, v112, v65
    v_mul_f32 v113, v113, v65
    v_mul_f32 v114, v114, v65
    v_mul_f32 v115, v115, v65
    v_mul_f32 v116, v116, v66
    v_mul_f32 v117, v117, v66
    v_mul_f32 v118, v118, v66
    v_mul_f32 v119, v119, v66
    v_mul_f32 v120, v120, v67
    v_mul_f32 v121, v121, v67
    v_mul_f32 v122, v122, v67
    v_mul_f32 v123, v123, v67
    s_or_b32 s23, s21, s22
    s_cbranch_scc1 adaLN_cond__spectral_fnet__mixer_gmlp__prompt_kernel_bnodc
    v_and_b32 v10, 0x1cf, v0
    v_lshlrev_b32 v10, 2, v10
    global_load_dword v76, v10, s[4:5] offset:0 sc1
    global_load_dword v77, v10, s[4:5] offset:64 sc1
    global_load_dword v78, v10, s[4:5] offset:128 sc1
    global_load_dword v79, v10, s[4:5] offset:192 sc1
    v_cmp_eq_u32 vcc, 0, v2
    v_mov_b32 v9, 0x45000000
    s_nop 0
    v_cndmask_b32 v9, 0, v9, vcc
    s_waitcnt vmcnt(0)
    v_fmac_f32 v108, v76, v9
    v_fmac_f32 v112, v77, v9
    v_fmac_f32 v116, v78, v9
    v_fmac_f32 v120, v79, v9
adaLN_cond__spectral_fnet__mixer_gmlp__prompt_kernel_bnodc:
    v_cvt_pk_bf16_f32 v108, v108, v109
    v_cvt_pk_bf16_f32 v109, v110, v111
    ds_write_b32 v149, v108 offset:0
    ds_write_b32 v149, v109 offset:2560
    v_cvt_pk_bf16_f32 v112, v112, v113
    v_cvt_pk_bf16_f32 v113, v114, v115
    ds_write_b32 v149, v112 offset:1280
    ds_write_b32 v149, v113 offset:3840
    v_cvt_pk_bf16_f32 v116, v116, v117
    v_cvt_pk_bf16_f32 v117, v118, v119
    ds_write_b32 v149, v116 offset:4
    ds_write_b32 v149, v117 offset:2564
    v_cvt_pk_bf16_f32 v120, v120, v121
    v_cvt_pk_bf16_f32 v121, v122, v123
    ds_write_b32 v149, v120 offset:1284
    ds_write_b32 v149, v121 offset:3844
    s_mov_b32 s23, 0xffff0000
    s_waitcnt lgkmcnt(0)
    s_barrier
    ds_read_b128 v[76:79], v150 offset:0
    ds_read_b128 v[84:87], v150 offset:1280
    ds_read_b128 v[32:35], v4 offset:2048
    ds_read_b128 v[36:39], v4 offset:3072
    ds_read_b128 v[40:43], v4 offset:4096
    ds_read_b128 v[44:47], v4 offset:5120
    v_lshlrev_b32 v15, 1, v4
    s_waitcnt lgkmcnt(5)
    v_mfma_f32_16x16x32_bf16 v[108:111], v[24:27], v[76:79], 0
    v_mfma_f32_16x16x32_bf16 v[112:115], v[28:31], v[76:79], 0
    s_waitcnt lgkmcnt(4)
    v_mfma_f32_16x16x32_bf16 v[116:119], v[24:27], v[84:87], 0
    v_mfma_f32_16x16x32_bf16 v[120:123], v[28:31], v[84:87], 0
    ds_read_b128 v[124:127], v15 offset:12288
    ds_read_b128 v[128:131], v15 offset:12304
    ds_read_b128 v[132:135], v15 offset:14336
    ds_read_b128 v[136:139], v15 offset:14352
    ds_read_b128 v[140:143], v15 offset:16384
    ds_read_b128 v[144:147], v15 offset:16400
    v_mul_f32 v8, v108, v48
    v_mul_f32 v9, v109, v48
    v_fma_f32 v8, v109, v49, v8
    v_fma_f32 v9, -v108, v49, v9
    v_cvt_pk_bf16_f32 v10, v8, v9
    ds_write_b32 v151, v10 offset:19456
    v_mul_f32 v12, v110, v50
    v_mul_f32 v13, v111, v50
    v_fma_f32 v12, v111, v51, v12
    v_fma_f32 v13, -v110, v51, v13
    v_cvt_pk_bf16_f32 v14, v12, v13
    ds_write_b32 v151, v14 offset:19600
    v_mul_f32 v8, v112, v52
    v_mul_f32 v9, v113, v52
    v_fma_f32 v8, v113, v53, v8
    v_fma_f32 v9, -v112, v53, v9
    v_cvt_pk_bf16_f32 v10, v8, v9
    ds_write_b32 v151, v10 offset:20608
    v_mul_f32 v12, v114, v54
    v_mul_f32 v13, v115, v54
    v_fma_f32 v12, v115, v55, v12
    v_fma_f32 v13, -v114, v55, v13
    v_cvt_pk_bf16_f32 v14, v12, v13
    ds_write_b32 v151, v14 offset:20752
    v_mul_f32 v8, v116, v56
    v_mul_f32 v9, v117, v56
    v_fma_f32 v8, v117, v57, v8
    v_fma_f32 v9, -v116, v57, v9
    v_cvt_pk_bf16_f32 v10, v8, v9
    ds_write_b32 v151, v10 offset:19520
    v_mul_f32 v12, v118, v58
    v_mul_f32 v13, v119, v58
    v_fma_f32 v12, v119, v59, v12
    v_fma_f32 v13, -v118, v59, v13
    v_cvt_pk_bf16_f32 v14, v12, v13
    ds_write_b32 v151, v14 offset:19664
    v_mul_f32 v8, v120, v60
    v_mul_f32 v9, v121, v60
    v_fma_f32 v8, v121, v61, v8
    v_fma_f32 v9, -v120, v61, v9
    v_cvt_pk_bf16_f32 v10, v8, v9
    ds_write_b32 v151, v10 offset:20672
    v_mul_f32 v12, v122, v62
    v_mul_f32 v13, v123, v62
    v_fma_f32 v12, v123, v63, v12
    v_fma_f32 v13, -v122, v63, v13
    v_cvt_pk_bf16_f32 v14, v12, v13
    ds_write_b32 v151, v14 offset:20816
    s_waitcnt lgkmcnt(0)
    ds_read_b128 v[76:79], v152 offset:19456
    ds_read_b128 v[84:87], v152 offset:19520
    s_waitcnt vmcnt(1)
    v_lshlrev_b32 v156, 16, v68
    v_and_b32 v157, s23, v68
    v_lshlrev_b32 v158, 16, v69
    v_and_b32 v159, s23, v69
    v_lshlrev_b32 v160, 16, v70
    v_and_b32 v161, s23, v70
    v_lshlrev_b32 v162, 16, v71
    v_and_b32 v163, s23, v71
    v_lshlrev_b32 v164, 16, v72
    v_and_b32 v165, s23, v72
    v_lshlrev_b32 v166, 16, v73
    v_and_b32 v167, s23, v73
    v_lshlrev_b32 v168, 16, v74
    v_and_b32 v169, s23, v74
    v_lshlrev_b32 v170, 16, v75
    v_and_b32 v171, s23, v75
    s_waitcnt lgkmcnt(1)
    v_mfma_f32_16x16x32_bf16 v[108:111], v[76:79], v[32:35], 0
    v_mfma_f32_16x16x32_bf16 v[112:115], v[76:79], v[40:43], 0
    s_waitcnt lgkmcnt(0)
    v_mfma_f32_16x16x32_bf16 v[108:111], v[84:87], v[36:39], v[108:111]
    v_mfma_f32_16x16x32_bf16 v[112:115], v[84:87], v[44:47], v[112:115]
    v_lshl_add_u32 v8, v4, 1, s49
    v_lshlrev_b32 v10, 1, v4
    v_sub_u32 v9, 2048, v10
    v_and_b32 v9, 2047, v9
    v_add_u32 v9, s49, v9
    s_add_u32 s24, s49, 2020
    v_sub_u32 v10, s24, v10
    ds_write_b128 v153, v[108:111] offset:0
    ds_write_b128 v153, v[112:115] offset:1024
    s_waitcnt lgkmcnt(0)
    ds_read_b128 v[92:95], v8
    ds_read_b128 v[96:99], v8 offset:16
    ds_read_b32 v100, v9
    ds_read_b32 v101, v10 offset:24
    ds_read2_b32 v[102:103], v10 offset0:5 offset1:4
    ds_read2_b32 v[104:105], v10 offset0:3 offset1:2
    ds_read2_b32 v[106:107], v10 offset0:1 offset1:0
    s_waitcnt lgkmcnt(5)
    v_fma_f32 v156, v124, v92, v156
    v_fma_f32 v157, v125, v93, v157
    v_fma_f32 v158, v126, v94, v158
    v_fma_f32 v159, v127, v95, v159
    v_fma_f32 v160, v128, v96, v160
    v_fma_f32 v161, v129, v97, v161
    v_fma_f32 v162, v130, v98, v162
    v_fma_f32 v163, v131, v99, v163
    s_waitcnt lgkmcnt(0)
    v_fma_f32 v164, v124, v100, v164
    v_fma_f32 v165, v125, v101, v165
    v_fma_f32 v166, v126, v102, v166
    v_fma_f32 v167, v127, v103, v167
    v_fma_f32 v168, v128, v104, v168
    v_fma_f32 v169, v129, v105, v169
    v_fma_f32 v170, v130, v106, v170
    v_fma_f32 v171, v131, v107, v171
    v_cvt_pk_bf16_f32 v68, v156, v157
    v_cvt_pk_bf16_f32 v69, v158, v159
    v_cvt_pk_bf16_f32 v70, v160, v161
    v_cvt_pk_bf16_f32 v71, v162, v163
    v_cvt_pk_bf16_f32 v72, v164, v165
    v_cvt_pk_bf16_f32 v73, v166, v167
    v_cvt_pk_bf16_f32 v74, v168, v169
    v_cvt_pk_bf16_f32 v75, v170, v171
    v_add_u32 v10, 8388608, v154
    v_add_u32 v11, 8388608, v155
    global_store_dwordx4 v10, v[68:71], s[4:5] sc1
    s_cmp_eq_u32 s27, 0
    s_cbranch_scc1 adaLN_cond__spectral_fnet__mixer_gmlp__prompt_kernel_bnomir1
    global_store_dwordx4 v11, v[72:75], s[4:5] sc1
adaLN_cond__spectral_fnet__mixer_gmlp__prompt_kernel_bnomir1:
    v_lshlrev_b32 v156, 16, v68
    v_and_b32 v157, s23, v68
    v_lshlrev_b32 v158, 16, v69
    v_and_b32 v159, s23, v69
    v_lshlrev_b32 v160, 16, v70
    v_and_b32 v161, s23, v70
    v_lshlrev_b32 v162, 16, v71
    v_and_b32 v163, s23, v71
    v_lshlrev_b32 v164, 16, v72
    v_and_b32 v165, s23, v72
    v_lshlrev_b32 v166, 16, v73
    v_and_b32 v167, s23, v73
    v_lshlrev_b32 v168, 16, v74
    v_and_b32 v169, s23, v74
    v_lshlrev_b32 v170, 16, v75
    v_and_b32 v171, s23, v75
    v_add_f32 v8, v156, v157
    v_mul_f32 v12, v156, v156
    v_add_f32 v9, v164, v165
    v_mul_f32 v13, v164, v164
    v_fmac_f32 v12, v157, v157
    v_fmac_f32 v13, v165, v165
    v_add_f32 v8, v8, v158
    v_fmac_f32 v12, v158, v158
    v_add_f32 v9, v9, v166
    v_fmac_f32 v13, v166, v166
    v_add_f32 v8, v8, v159
    v_fmac_f32 v12, v159, v159
    v_add_f32 v9, v9, v167
    v_fmac_f32 v13, v167, v167
    v_add_f32 v8, v8, v160
    v_fmac_f32 v12, v160, v160
    v_add_f32 v9, v9, v168
    v_fmac_f32 v13, v168, v168
    v_add_f32 v8, v8, v161
    v_fmac_f32 v12, v161, v161
    v_add_f32 v9, v9, v169
    v_fmac_f32 v13, v169, v169
    v_add_f32 v8, v8, v162
    v_fmac_f32 v12, v162, v162
    v_add_f32 v9, v9, v170
    v_fmac_f32 v13, v170, v170
    v_add_f32 v8, v8, v163
    v_fmac_f32 v12, v163, v163
    v_add_f32 v9, v9, v171
    v_fmac_f32 v13, v171, v171
    v_add_f32_dpp v8, v8, v8 quad_perm:[1,0,3,2] row_mask:0xf bank_mask:0xf
    v_add_f32_dpp v12, v12, v12 quad_perm:[1,0,3,2] row_mask:0xf bank_mask:0xf
    v_add_f32_dpp v9, v9, v9 quad_perm:[1,0,3,2] row_mask:0xf bank_mask:0xf
    v_add_f32_dpp v13, v13, v13 quad_perm:[1,0,3,2] row_mask:0xf bank_mask:0xf
    v_add_f32_dpp v8, v8, v8 quad_perm:[2,3,0,1] row_mask:0xf bank_mask:0xf
    v_add_f32_dpp v12, v12, v12 quad_perm:[2,3,0,1] row_mask:0xf bank_mask:0xf
    v_add_f32_dpp v9, v9, v9 quad_perm:[2,3,0,1] row_mask:0xf bank_mask:0xf
    v_add_f32_dpp v13, v13, v13 quad_perm:[2,3,0,1] row_mask:0xf bank_mask:0xf
    v_add_f32_dpp v8, v8, v8 row_half_mirror row_mask:0xf bank_mask:0xf
    v_add_f32_dpp v12, v12, v12 row_half_mirror row_mask:0xf bank_mask:0xf
    v_add_f32_dpp v9, v9, v9 row_half_mirror row_mask:0xf bank_mask:0xf
    v_add_f32_dpp v13, v13, v13 row_half_mirror row_mask:0xf bank_mask:0xf
    v_add_f32_dpp v8, v8, v8 row_mirror row_mask:0xf bank_mask:0xf
    v_add_f32_dpp v12, v12, v12 row_mirror row_mask:0xf bank_mask:0xf
    v_add_f32_dpp v9, v9, v9 row_mirror row_mask:0xf bank_mask:0xf
    v_add_f32_dpp v13, v13, v13 row_mirror row_mask:0xf bank_mask:0xf
    v_add_f32_dpp v8, v8, v8 row_bcast:15 row_mask:0xa bank_mask:0xf
    v_add_f32_dpp v12, v12, v12 row_bcast:15 row_mask:0xa bank_mask:0xf
    v_add_f32_dpp v9, v9, v9 row_bcast:15 row_mask:0xa bank_mask:0xf
    v_add_f32_dpp v13, v13, v13 row_bcast:15 row_mask:0xa bank_mask:0xf
    v_add_f32_dpp v8, v8, v8 row_bcast:31 row_mask:0xc bank_mask:0xf
    v_add_f32_dpp v12, v12, v12 row_bcast:31 row_mask:0xc bank_mask:0xf
    v_add_f32_dpp v9, v9, v9 row_bcast:31 row_mask:0xc bank_mask:0xf
    v_add_f32_dpp v13, v13, v13 row_bcast:31 row_mask:0xc bank_mask:0xf
    v_readlane_b32 s30, v8, 63
    v_readlane_b32 s31, v12, 63
    v_readlane_b32 s32, v9, 63
    v_readlane_b32 s33, v13, 63
    v_mov_b32 v14, 0x3b000000
    v_mul_f32 v8, s30, v14
    v_mul_f32 v12, s31, v14
    v_mul_f32 v9, s32, v14
    v_mul_f32 v13, s33, v14
    v_fma_f32 v12, -v8, v8, v12
    v_fma_f32 v13, -v9, v9, v13
    v_max_f32 v12, 0, v12
    v_max_f32 v13, 0, v13
    v_add_f32 v12, 0x3727c5ac, v12
    v_add_f32 v13, 0x3727c5ac, v13
    v_rsq_f32 v12, v12
    v_rsq_f32 v13, v13
    v_add_u32 v10, 12582912, v154
    v_add_u32 v11, 12582912, v155
    v_sub_f32 v156, v156, v8
    v_sub_f32 v157, v157, v8
    v_sub_f32 v158, v158, v8
    v_sub_f32 v159, v159, v8
    v_sub_f32 v160, v160, v8
    v_sub_f32 v161, v161, v8
    v_sub_f32 v162, v162, v8
    v_sub_f32 v163, v163, v8
    v_sub_f32 v164, v164, v9
    v_sub_f32 v165, v165, v9
    v_sub_f32 v166, v166, v9
    v_sub_f32 v167, v167, v9
    v_sub_f32 v168, v168, v9
    v_sub_f32 v169, v169, v9
    v_sub_f32 v170, v170, v9
    v_sub_f32 v171, v171, v9
    v_mul_f32 v156, v156, v12
    v_mul_f32 v157, v157, v12
    v_mul_f32 v158, v158, v12
    v_mul_f32 v159, v159, v12
    v_mul_f32 v160, v160, v12
    v_mul_f32 v161, v161, v12
    v_mul_f32 v162, v162, v12
    v_mul_f32 v163, v163, v12
    v_mul_f32 v164, v164, v13
    v_mul_f32 v165, v165, v13
    v_mul_f32 v166, v166, v13
    v_mul_f32 v167, v167, v13
    v_mul_f32 v168, v168, v13
    v_mul_f32 v169, v169, v13
    v_mul_f32 v170, v170, v13
    v_mul_f32 v171, v171, v13
    v_fma_f32 v156, v156, v140, v132
    v_fma_f32 v157, v157, v141, v133
    v_fma_f32 v158, v158, v142, v134
    v_fma_f32 v159, v159, v143, v135
    v_fma_f32 v160, v160, v144, v136
    v_fma_f32 v161, v161, v145, v137
    v_fma_f32 v162, v162, v146, v138
    v_fma_f32 v163, v163, v147, v139
    v_fma_f32 v164, v164, v140, v132
    v_fma_f32 v165, v165, v141, v133
    v_fma_f32 v166, v166, v142, v134
    v_fma_f32 v167, v167, v143, v135
    v_fma_f32 v168, v168, v144, v136
    v_fma_f32 v169, v169, v145, v137
    v_fma_f32 v170, v170, v146, v138
    v_fma_f32 v171, v171, v147, v139
    v_cvt_pk_bf16_f32 v92, v156, v157
    v_cvt_pk_bf16_f32 v93, v158, v159
    v_cvt_pk_bf16_f32 v94, v160, v161
    v_cvt_pk_bf16_f32 v95, v162, v163
    v_cvt_pk_bf16_f32 v100, v164, v165
    v_cvt_pk_bf16_f32 v101, v166, v167
    v_cvt_pk_bf16_f32 v102, v168, v169
    v_cvt_pk_bf16_f32 v103, v170, v171
    global_store_dwordx4 v10, v[92:95], s[4:5] sc1
    s_cmp_eq_u32 s27, 0
    s_cbranch_scc1 adaLN_cond__spectral_fnet__mixer_gmlp__prompt_kernel_bfin
    global_store_dwordx4 v11, v[100:103], s[4:5] sc1
adaLN_cond__spectral_fnet__mixer_gmlp__prompt_kernel_bfin:
    s_lshl_b32 s23, s2, 7
    s_add_u32 s23, s23, 360448
    v_mov_b32 v250, 159756
    v_mov_b32 v251, 1
    s_waitcnt vmcnt(0)
    s_mov_b64 exec, 1
    ds_add_rtn_u32 v250, v250, v251
    s_waitcnt lgkmcnt(0)
    v_readfirstlane_b32 s24, v250
    v_mov_b32 v250, s23
    v_mov_b32 v251, s64
    s_cmp_lg_u32 s24, 7
    s_cbranch_scc1 adaLN_cond__spectral_fnet__mixer_gmlp__prompt_kernel_noflb
    global_store_dword v250, v251, s[4:5] sc1
adaLN_cond__spectral_fnet__mixer_gmlp__prompt_kernel_noflb:
    s_mov_b64 exec, -1
    s_barrier
adaLN_cond__spectral_fnet__mixer_gmlp__prompt_kernel_bdone:
    s_bfe_u32 s21, s2, 0x20001
    s_bfe_u32 s23, s2, 0x30003
    s_lshl3_add_u32 s21, s21, s23
    s_and_b32 s22, s2, 1
    s_lshr_b32 s23, s2, 6
    s_lshl2_add_u32 s22, s22, s23
    s_and_b32 s26, s20, 1
    s_bfe_u32 s27, s20, 0x10001
    v_bfe_u32 v1, v0, 4, 2
    v_and_b32 v2, 15, v0
    s_lshl1_add_u32 s23, s26, s27
    s_xor_b32 s24, s23, 1
    v_lshl_add_u32 v3, s23, 4, v2
    v_lshl_add_u32 v4, s24, 4, v2
    s_cmp_ge_u32 s20, 4
    s_cbranch_scc1 adaLN_cond__spectral_fnet__mixer_gmlp__prompt_kernel_loader
    v_and_b32 v8, 7, v2
    v_xor_b32 v9, v1, v8
    v_lshlrev_b32 v9, 4, v9
    v_lshl_add_u32 v16, v3, 7, v9
    v_xor_b32 v17, 64, v16
    v_lshl_add_u32 v18, v4, 7, v9
    v_xor_b32 v19, 64, v18
    v_mul_u32_u24 v9, 1920, v1
    v_lshrrev_b32 v10, 2, v2
    v_mul_u32_u24 v10, 224, v10
    v_and_b32 v11, 3, v2
    v_lshl_add_u32 v9, v11, 3, v9
    v_add_u32 v9, v9, v10
    s_lshl_b32 s23, s27, 7
    s_add_u32 s23, s23, 65536
    v_add_u32 v20, s23, v9
    v_add_u32 v22, 65632, v9
    v_add_u32 v21, 46080, v20
    v_add_u32 v23, 46080, v22
    s_mul_i32 s23, s20, 4608
    s_add_u32 s23, s23, 126976
    v_and_b32 v24, 31, v3
    v_mul_u32_u24 v24, 144, v24
    v_lshl_add_u32 v24, v1, 3, v24
    v_add_u32 v24, s23, v24
    v_and_b32 v25, 31, v4
    v_mul_u32_u24 v25, 144, v25
    v_lshl_add_u32 v25, v1, 3, v25
    v_add_u32 v25, s23, v25
    v_mov_b32 v58, 0
    v_mov_b32 v62, 0
    v_mov_b32 v59, 0
    v_mov_b32 v63, 0
    v_mov_b32 v60, 0
    v_mov_b32 v64, 0
    v_mov_b32 v61, 0
    v_mov_b32 v65, 0
    v_mov_b32 v6, 0xbdd2d3e8
    v_mov_b32 v7, 0xc0135761
    s_waitcnt lgkmcnt(0)
    v_mov_b32 v68, 0
    v_mov_b32 v69, 0
    v_mov_b32 v70, 0
    v_mov_b32 v71, 0
    v_mov_b32 v72, 0
    v_mov_b32 v73, 0
    v_mov_b32 v74, 0
    v_mov_b32 v75, 0
    v_mov_b32 v76, 0
    v_mov_b32 v77, 0
    v_mov_b32 v78, 0
    v_mov_b32 v79, 0
    v_mov_b32 v80, 0
    v_mov_b32 v81, 0
    v_mov_b32 v82, 0
    v_mov_b32 v83, 0
    v_mov_b32 v84, 0
    v_mov_b32 v85, 0
    v_mov_b32 v86, 0
    v_mov_b32 v87, 0
    v_mov_b32 v88, 0
    v_mov_b32 v89, 0
    v_mov_b32 v90, 0
    v_mov_b32 v91, 0
    v_mov_b32 v92, 0
    v_mov_b32 v93, 0
    v_mov_b32 v94, 0
    v_mov_b32 v95, 0
    s_mov_b32 s43, 0
    s_barrier
    s_barrier
    ds_read_b128 v[104:107], v16 offset:0
    ds_read_b128 v[108:111], v18 offset:0
    ds_read_b64_tr_b16 v[136:137], v20 offset:0
    ds_read_b64_tr_b16 v[138:139], v20 offset:960
    ds_read_b64_tr_b16 v[140:141], v20 offset:32
    ds_read_b64_tr_b16 v[142:143], v20 offset:992
    ds_read_b64_tr_b16 v[144:145], v20 offset:64
    ds_read_b64_tr_b16 v[146:147], v20 offset:1024
    ds_read_b64_tr_b16 v[148:149], v22 offset:0
    ds_read_b64_tr_b16 v[150:151], v22 offset:960
    ds_read_b128 v[112:115], v17 offset:0
    ds_read_b128 v[116:119], v19 offset:0
    ds_read_b64_tr_b16 v[152:153], v20 offset:7680
    ds_read_b64_tr_b16 v[154:155], v20 offset:8640
    ds_read_b64_tr_b16 v[156:157], v20 offset:7712
    ds_read_b64_tr_b16 v[158:159], v20 offset:8672
    ds_read_b64_tr_b16 v[160:161], v20 offset:7744
    ds_read_b64_tr_b16 v[162:163], v20 offset:8704
    ds_read_b64_tr_b16 v[164:165], v22 offset:7680
    ds_read_b64_tr_b16 v[166:167], v22 offset:8640
adaLN_cond__spectral_fnet__mixer_gmlp__prompt_kernel_zloop:
    s_and_b32 s23, s43, 1
    s_lshl_b32 s23, s23, 15
    s_xor_b32 s24, s23, 32768
    v_add_u32 v96, s23, v16
    v_add_u32 v100, s24, v16
    v_add_u32 v97, s23, v17
    v_add_u32 v101, s24, v17
    v_add_u32 v98, s23, v18
    v_add_u32 v102, s24, v18
    v_add_u32 v99, s23, v19
    v_add_u32 v103, s24, v19
    s_waitcnt lgkmcnt(0)
    s_barrier
    v_mfma_f32_16x16x32_bf16 v[68:71], v[136:139], v[104:107], v[68:71]
    ds_read_b128 v[120:123], v96 offset:8192
    ds_read_b128 v[124:127], v98 offset:8192
    v_mfma_f32_16x16x32_bf16 v[72:75], v[136:139], v[108:111], v[72:75]
    ds_read_b64_tr_b16 v[168:169], v20 offset:15360
    ds_read_b64_tr_b16 v[170:171], v20 offset:16320
    v_mfma_f32_16x16x32_bf16 v[76:79], v[140:143], v[104:107], v[76:79]
    ds_read_b64_tr_b16 v[172:173], v20 offset:15392
    ds_read_b64_tr_b16 v[174:175], v20 offset:16352
    v_mfma_f32_16x16x32_bf16 v[80:83], v[140:143], v[108:111], v[80:83]
    ds_read_b64_tr_b16 v[176:177], v20 offset:15424
    ds_read_b64_tr_b16 v[178:179], v20 offset:16384
    v_mfma_f32_16x16x32_bf16 v[84:87], v[144:147], v[104:107], v[84:87]
    ds_read_b64_tr_b16 v[180:181], v22 offset:15360
    ds_read_b64_tr_b16 v[182:183], v22 offset:16320
    v_mfma_f32_16x16x32_bf16 v[88:91], v[144:147], v[108:111], v[88:91]
    ds_read_b128 v[128:131], v97 offset:8192
    ds_read_b128 v[132:135], v99 offset:8192
    v_mfma_f32_16x16x32_bf16 v[92:95], v[148:151], v[104:107], v[92:95]
    ds_read_b64_tr_b16 v[184:185], v20 offset:23040
    ds_read_b64_tr_b16 v[186:187], v20 offset:24000
    v_mfma_f32_16x16x32_bf16 v[68:71], v[152:155], v[112:115], v[68:71]
    ds_read_b64_tr_b16 v[188:189], v20 offset:23072
    ds_read_b64_tr_b16 v[190:191], v20 offset:24032
    v_mfma_f32_16x16x32_bf16 v[72:75], v[152:155], v[116:119], v[72:75]
    ds_read_b64_tr_b16 v[192:193], v20 offset:23104
    ds_read_b64_tr_b16 v[194:195], v20 offset:24064
    v_mfma_f32_16x16x32_bf16 v[76:79], v[156:159], v[112:115], v[76:79]
    ds_read_b64_tr_b16 v[196:197], v22 offset:23040
    ds_read_b64_tr_b16 v[198:199], v22 offset:24000
    v_mfma_f32_16x16x32_bf16 v[80:83], v[156:159], v[116:119], v[80:83]
    v_mfma_f32_16x16x32_bf16 v[84:87], v[160:163], v[112:115], v[84:87]
    v_mfma_f32_16x16x32_bf16 v[88:91], v[160:163], v[116:119], v[88:91]
    v_mfma_f32_16x16x32_bf16 v[92:95], v[164:167], v[112:115], v[92:95]
    s_waitcnt lgkmcnt(0)
    s_barrier
    v_mfma_f32_16x16x32_bf16 v[68:71], v[168:171], v[120:123], v[68:71]
    ds_read_b128 v[104:107], v96 offset:16384
    ds_read_b128 v[108:111], v98 offset:16384
    v_mfma_f32_16x16x32_bf16 v[72:75], v[168:171], v[124:127], v[72:75]
    ds_read_b64_tr_b16 v[136:137], v20 offset:30720
    ds_read_b64_tr_b16 v[138:139], v20 offset:31680
    v_mfma_f32_16x16x32_bf16 v[76:79], v[172:175], v[120:123], v[76:79]
    ds_read_b64_tr_b16 v[140:141], v20 offset:30752
    ds_read_b64_tr_b16 v[142:143], v20 offset:31712
    v_mfma_f32_16x16x32_bf16 v[80:83], v[172:175], v[124:127], v[80:83]
    ds_read_b64_tr_b16 v[144:145], v20 offset:30784
    ds_read_b64_tr_b16 v[146:147], v20 offset:31744
    v_mfma_f32_16x16x32_bf16 v[84:87], v[176:179], v[120:123], v[84:87]
    ds_read_b64_tr_b16 v[148:149], v22 offset:30720
    ds_read_b64_tr_b16 v[150:151], v22 offset:31680
    v_mfma_f32_16x16x32_bf16 v[88:91], v[176:179], v[124:127], v[88:91]
    ds_read_b128 v[112:115], v97 offset:16384
    ds_read_b128 v[116:119], v99 offset:16384
    v_mfma_f32_16x16x32_bf16 v[92:95], v[180:183], v[120:123], v[92:95]
    ds_read_b64_tr_b16 v[152:153], v20 offset:38400
    ds_read_b64_tr_b16 v[154:155], v20 offset:39360
    v_mfma_f32_16x16x32_bf16 v[68:71], v[184:187], v[128:131], v[68:71]
    ds_read_b64_tr_b16 v[156:157], v20 offset:38432
    ds_read_b64_tr_b16 v[158:159], v20 offset:39392
    v_mfma_f32_16x16x32_bf16 v[72:75], v[184:187], v[132:135], v[72:75]
    ds_read_b64_tr_b16 v[160:161], v20 offset:38464
    ds_read_b64_tr_b16 v[162:163], v20 offset:39424
    v_mfma_f32_16x16x32_bf16 v[76:79], v[188:191], v[128:131], v[76:79]
    ds_read_b64_tr_b16 v[164:165], v22 offset:38400
    ds_read_b64_tr_b16 v[166:167], v22 offset:39360
    v_mfma_f32_16x16x32_bf16 v[80:83], v[188:191], v[132:135], v[80:83]
    v_mfma_f32_16x16x32_bf16 v[84:87], v[192:195], v[128:131], v[84:87]
    v_mfma_f32_16x16x32_bf16 v[88:91], v[192:195], v[132:135], v[88:91]
    v_mfma_f32_16x16x32_bf16 v[92:95], v[196:199], v[128:131], v[92:95]
    s_waitcnt lgkmcnt(0)
    s_barrier
    v_mfma_f32_16x16x32_bf16 v[68:71], v[136:139], v[104:107], v[68:71]
    ds_read_b128 v[120:123], v96 offset:24576
    ds_read_b128 v[124:127], v98 offset:24576
    v_mfma_f32_16x16x32_bf16 v[72:75], v[136:139], v[108:111], v[72:75]
    ds_read_b64_tr_b16 v[168:169], v21 offset:0
    ds_read_b64_tr_b16 v[170:171], v21 offset:960
    v_mfma_f32_16x16x32_bf16 v[76:79], v[140:143], v[104:107], v[76:79]
    ds_read_b64_tr_b16 v[172:173], v21 offset:32
    ds_read_b64_tr_b16 v[174:175], v21 offset:992
    v_mfma_f32_16x16x32_bf16 v[80:83], v[140:143], v[108:111], v[80:83]
    ds_read_b64_tr_b16 v[176:177], v21 offset:64
    ds_read_b64_tr_b16 v[178:179], v21 offset:1024
    v_mfma_f32_16x16x32_bf16 v[84:87], v[144:147], v[104:107], v[84:87]
    ds_read_b64_tr_b16 v[180:181], v23 offset:0
    ds_read_b64_tr_b16 v[182:183], v23 offset:960
    v_mfma_f32_16x16x32_bf16 v[88:91], v[144:147], v[108:111], v[88:91]
    ds_read_b128 v[128:131], v97 offset:24576
    ds_read_b128 v[132:135], v99 offset:24576
    v_mfma_f32_16x16x32_bf16 v[92:95], v[148:151], v[104:107], v[92:95]
    ds_read_b64_tr_b16 v[184:185], v21 offset:7680
    ds_read_b64_tr_b16 v[186:187], v21 offset:8640
    v_mfma_f32_16x16x32_bf16 v[68:71], v[152:155], v[112:115], v[68:71]
    ds_read_b64_tr_b16 v[188:189], v21 offset:7712
    ds_read_b64_tr_b16 v[190:191], v21 offset:8672
    v_mfma_f32_16x16x32_bf16 v[72:75], v[152:155], v[116:119], v[72:75]
    ds_read_b64_tr_b16 v[192:193], v21 offset:7744
    ds_read_b64_tr_b16 v[194:195], v21 offset:8704
    v_mfma_f32_16x16x32_bf16 v[76:79], v[156:159], v[112:115], v[76:79]
    ds_read_b64_tr_b16 v[196:197], v23 offset:7680
    ds_read_b64_tr_b16 v[198:199], v23 offset:8640
    v_mfma_f32_16x16x32_bf16 v[80:83], v[156:159], v[116:119], v[80:83]
    v_mfma_f32_16x16x32_bf16 v[84:87], v[160:163], v[112:115], v[84:87]
    v_mfma_f32_16x16x32_bf16 v[88:91], v[160:163], v[116:119], v[88:91]
    v_mfma_f32_16x16x32_bf16 v[92:95], v[164:167], v[112:115], v[92:95]
    s_waitcnt lgkmcnt(0)
    s_barrier
    v_mfma_f32_16x16x32_bf16 v[68:71], v[168:171], v[120:123], v[68:71]
    ds_read_b128 v[104:107], v100 offset:0
    ds_read_b128 v[108:111], v102 offset:0
    v_mfma_f32_16x16x32_bf16 v[72:75], v[168:171], v[124:127], v[72:75]
    ds_read_b64_tr_b16 v[136:137], v20 offset:0
    ds_read_b64_tr_b16 v[138:139], v20 offset:960
    v_mfma_f32_16x16x32_bf16 v[76:79], v[172:175], v[120:123], v[76:79]
    ds_read_b64_tr_b16 v[140:141], v20 offset:32
    ds_read_b64_tr_b16 v[142:143], v20 offset:992
    v_mfma_f32_16x16x32_bf16 v[80:83], v[172:175], v[124:127], v[80:83]
    ds_read_b64_tr_b16 v[144:145], v20 offset:64
    ds_read_b64_tr_b16 v[146:147], v20 offset:1024
    v_mfma_f32_16x16x32_bf16 v[84:87], v[176:179], v[120:123], v[84:87]
    ds_read_b64_tr_b16 v[148:149], v22 offset:0
    ds_read_b64_tr_b16 v[150:151], v22 offset:960
    v_mfma_f32_16x16x32_bf16 v[88:91], v[176:179], v[124:127], v[88:91]
    ds_read_b128 v[112:115], v101 offset:0
    ds_read_b128 v[116:119], v103 offset:0
    v_mfma_f32_16x16x32_bf16 v[92:95], v[180:183], v[120:123], v[92:95]
    ds_read_b64_tr_b16 v[152:153], v20 offset:7680
    ds_read_b64_tr_b16 v[154:155], v20 offset:8640
    v_mfma_f32_16x16x32_bf16 v[68:71], v[184:187], v[128:131], v[68:71]
    ds_read_b64_tr_b16 v[156:157], v20 offset:7712
    ds_read_b64_tr_b16 v[158:159], v20 offset:8672
    v_mfma_f32_16x16x32_bf16 v[72:75], v[184:187], v[132:135], v[72:75]
    ds_read_b64_tr_b16 v[160:161], v20 offset:7744
    ds_read_b64_tr_b16 v[162:163], v20 offset:8704
    v_mfma_f32_16x16x32_bf16 v[76:79], v[188:191], v[128:131], v[76:79]
    ds_read_b64_tr_b16 v[164:165], v22 offset:7680
    ds_read_b64_tr_b16 v[166:167], v22 offset:8640
    v_mfma_f32_16x16x32_bf16 v[80:83], v[188:191], v[132:135], v[80:83]
    v_mfma_f32_16x16x32_bf16 v[84:87], v[192:195], v[128:131], v[84:87]
    v_mfma_f32_16x16x32_bf16 v[88:91], v[192:195], v[132:135], v[88:91]
    v_mfma_f32_16x16x32_bf16 v[92:95], v[196:199], v[128:131], v[92:95]
    s_add_u32 s43, s43, 1
    s_cmp_lg_u32 s43, 2
    s_cbranch_scc1 adaLN_cond__spectral_fnet__mixer_gmlp__prompt_kernel_zcont
    v_and_b32 v13, 63, v0
    s_lshr_b32 s24, s2, 3
    s_lshl2_add_u32 s24, s24, s20
    s_bfe_u32 s23, s2, 0x20001
    s_lshl_b32 s23, s23, 21
    s_lshl_b32 s25, s24, 14
    s_add_u32 s23, s23, s25
    s_and_b32 s25, s2, 1
    s_lshl_b32 s25, s25, 13
    s_add_u32 s23, s23, s25
    v_lshl_add_u32 v9, v13, 7, s23
    global_load_dword v252, v9, s[12:13] sc1
    s_cmp_ge_u32 s24, 56
    s_cbranch_scc1 adaLN_cond__spectral_fnet__mixer_gmlp__prompt_kernel_nowo
    v_lshl_add_u32 v9, s24, 6, v13
    v_lshrrev_b32 v10, 2, v9
    v_and_b32 v9, 3, v9
    v_lshlrev_b32 v10, 10, v10
    v_lshl_add_u32 v10, v9, 7, v10
    s_and_b32 s23, s2, 1
    s_lshl_b32 s23, s23, 9
    v_add_u32 v10, s23, v10
    global_load_dword v254, v10, s[16:17] sc1
adaLN_cond__spectral_fnet__mixer_gmlp__prompt_kernel_nowo:
    s_mov_b32 s25, 0xffff0000
    v_pk_mul_f32 v[28:29], v[68:69], v[68:69]
    v_pk_mul_f32 v[30:31], v[70:71], v[70:71]
    v_pk_mul_f32 v[32:33], v[72:73], v[72:73]
    v_pk_mul_f32 v[34:35], v[74:75], v[74:75]
    v_pk_mul_f32 v[36:37], v[76:77], v[76:77]
    v_pk_mul_f32 v[38:39], v[78:79], v[78:79]
    v_pk_mul_f32 v[40:41], v[80:81], v[80:81]
    v_pk_mul_f32 v[42:43], v[82:83], v[82:83]
    v_pk_fma_f32 v[28:29], v[28:29], v[6:7], v[6:7] op_sel:[0,0,1] op_sel_hi:[1,0,1]
    v_pk_fma_f32 v[30:31], v[30:31], v[6:7], v[6:7] op_sel:[0,0,1] op_sel_hi:[1,0,1]
    v_pk_fma_f32 v[32:33], v[32:33], v[6:7], v[6:7] op_sel:[0,0,1] op_sel_hi:[1,0,1]
    v_pk_fma_f32 v[34:35], v[34:35], v[6:7], v[6:7] op_sel:[0,0,1] op_sel_hi:[1,0,1]
    v_pk_fma_f32 v[36:37], v[36:37], v[6:7], v[6:7] op_sel:[0,0,1] op_sel_hi:[1,0,1]
    v_pk_fma_f32 v[38:39], v[38:39], v[6:7], v[6:7] op_sel:[0,0,1] op_sel_hi:[1,0,1]
    v_pk_fma_f32 v[40:41], v[40:41], v[6:7], v[6:7] op_sel:[0,0,1] op_sel_hi:[1,0,1]
    v_pk_fma_f32 v[42:43], v[42:43], v[6:7], v[6:7] op_sel:[0,0,1] op_sel_hi:[1,0,1]
    v_pk_mul_f32 v[28:29], v[28:29], v[68:69]
    v_pk_mul_f32 v[30:31], v[30:31], v[70:71]
    v_pk_mul_f32 v[32:33], v[32:33], v[72:73]
    v_pk_mul_f32 v[34:35], v[34:35], v[74:75]
    v_pk_mul_f32 v[36:37], v[36:37], v[76:77]
    v_pk_mul_f32 v[38:39], v[38:39], v[78:79]
    v_pk_mul_f32 v[40:41], v[40:41], v[80:81]
    v_pk_mul_f32 v[42:43], v[42:43], v[82:83]
    v_exp_f32 v28, v28
    v_exp_f32 v29, v29
    v_exp_f32 v30, v30
    v_exp_f32 v31, v31
    v_exp_f32 v32, v32
    v_exp_f32 v33, v33
    v_exp_f32 v34, v34
    v_exp_f32 v35, v35
    v_exp_f32 v36, v36
    v_exp_f32 v37, v37
    v_exp_f32 v38, v38
    v_exp_f32 v39, v39
    v_exp_f32 v40, v40
    v_exp_f32 v41, v41
    v_exp_f32 v42, v42
    v_exp_f32 v43, v43
    v_pk_add_f32 v[28:29], v[28:29], 1.0 op_sel_hi:[1,0]
    v_pk_add_f32 v[30:31], v[30:31], 1.0 op_sel_hi:[1,0]
    v_pk_add_f32 v[32:33], v[32:33], 1.0 op_sel_hi:[1,0]
    v_pk_add_f32 v[34:35], v[34:35], 1.0 op_sel_hi:[1,0]
    v_pk_add_f32 v[36:37], v[36:37], 1.0 op_sel_hi:[1,0]
    v_pk_add_f32 v[38:39], v[38:39], 1.0 op_sel_hi:[1,0]
    v_pk_add_f32 v[40:41], v[40:41], 1.0 op_sel_hi:[1,0]
    v_pk_add_f32 v[42:43], v[42:43], 1.0 op_sel_hi:[1,0]
    v_rcp_f32 v28, v28
    v_rcp_f32 v29, v29
    v_rcp_f32 v30, v30
    v_rcp_f32 v31, v31
    v_rcp_f32 v32, v32
    v_rcp_f32 v33, v33
    v_rcp_f32 v34, v34
    v_rcp_f32 v35, v35
    v_rcp_f32 v36, v36
    v_rcp_f32 v37, v37
    v_rcp_f32 v38, v38
    v_rcp_f32 v39, v39
    v_rcp_f32 v40, v40
    v_rcp_f32 v41, v41
    v_rcp_f32 v42, v42
    v_rcp_f32 v43, v43
    v_pk_mul_f32 v[68:69], v[68:69], v[28:29]
    v_pk_mul_f32 v[70:71], v[70:71], v[30:31]
    v_pk_mul_f32 v[72:73], v[72:73], v[32:33]
    v_pk_mul_f32 v[74:75], v[74:75], v[34:35]
    v_pk_mul_f32 v[76:77], v[76:77], v[36:37]
    v_pk_mul_f32 v[78:79], v[78:79], v[38:39]
    v_pk_mul_f32 v[80:81], v[80:81], v[40:41]
    v_pk_mul_f32 v[82:83], v[82:83], v[42:43]
    v_cvt_pk_bf16_f32 v44, v68, v69
    v_cvt_pk_bf16_f32 v45, v70, v71
    v_cvt_pk_bf16_f32 v46, v72, v73
    v_cvt_pk_bf16_f32 v47, v74, v75
    v_cvt_pk_bf16_f32 v48, v76, v77
    v_cvt_pk_bf16_f32 v49, v78, v79
    v_cvt_pk_bf16_f32 v50, v80, v81
    v_cvt_pk_bf16_f32 v51, v82, v83
    v_lshlrev_b32 v28, 16, v44
    v_and_b32 v29, s25, v44
    v_lshlrev_b32 v30, 16, v45
    v_and_b32 v31, s25, v45
    v_lshlrev_b32 v32, 16, v46
    v_and_b32 v33, s25, v46
    v_lshlrev_b32 v34, 16, v47
    v_and_b32 v35, s25, v47
    v_lshlrev_b32 v36, 16, v48
    v_and_b32 v37, s25, v48
    v_lshlrev_b32 v38, 16, v49
    v_and_b32 v39, s25, v49
    v_lshlrev_b32 v40, 16, v50
    v_and_b32 v41, s25, v50
    v_lshlrev_b32 v42, 16, v51
    v_and_b32 v43, s25, v51
    v_pk_add_f32 v[58:59], v[58:59], v[28:29]
    v_pk_fma_f32 v[62:63], v[28:29], v[28:29], v[62:63]
    v_pk_add_f32 v[58:59], v[58:59], v[30:31]
    v_pk_fma_f32 v[62:63], v[30:31], v[30:31], v[62:63]
    v_pk_add_f32 v[60:61], v[60:61], v[32:33]
    v_pk_fma_f32 v[64:65], v[32:33], v[32:33], v[64:65]
    v_pk_add_f32 v[60:61], v[60:61], v[34:35]
    v_pk_fma_f32 v[64:65], v[34:35], v[34:35], v[64:65]
    v_pk_add_f32 v[58:59], v[58:59], v[36:37]
    v_pk_fma_f32 v[62:63], v[36:37], v[36:37], v[62:63]
    v_pk_add_f32 v[58:59], v[58:59], v[38:39]
    v_pk_fma_f32 v[62:63], v[38:39], v[38:39], v[62:63]
    v_pk_add_f32 v[60:61], v[60:61], v[40:41]
    v_pk_fma_f32 v[64:65], v[40:41], v[40:41], v[64:65]
    v_pk_add_f32 v[60:61], v[60:61], v[42:43]
    v_pk_fma_f32 v[64:65], v[42:43], v[42:43], v[64:65]
    v_pk_mul_f32 v[28:29], v[84:85], v[84:85]
    v_pk_mul_f32 v[30:31], v[86:87], v[86:87]
    v_pk_mul_f32 v[32:33], v[88:89], v[88:89]
    v_pk_mul_f32 v[34:35], v[90:91], v[90:91]
    v_pk_mul_f32 v[36:37], v[92:93], v[92:93]
    v_pk_mul_f32 v[38:39], v[94:95], v[94:95]
    v_pk_fma_f32 v[28:29], v[28:29], v[6:7], v[6:7] op_sel:[0,0,1] op_sel_hi:[1,0,1]
    v_pk_fma_f32 v[30:31], v[30:31], v[6:7], v[6:7] op_sel:[0,0,1] op_sel_hi:[1,0,1]
    v_pk_fma_f32 v[32:33], v[32:33], v[6:7], v[6:7] op_sel:[0,0,1] op_sel_hi:[1,0,1]
    v_pk_fma_f32 v[34:35], v[34:35], v[6:7], v[6:7] op_sel:[0,0,1] op_sel_hi:[1,0,1]
    v_pk_fma_f32 v[36:37], v[36:37], v[6:7], v[6:7] op_sel:[0,0,1] op_sel_hi:[1,0,1]
    v_pk_fma_f32 v[38:39], v[38:39], v[6:7], v[6:7] op_sel:[0,0,1] op_sel_hi:[1,0,1]
    v_pk_mul_f32 v[28:29], v[28:29], v[84:85]
    v_pk_mul_f32 v[30:31], v[30:31], v[86:87]
    v_pk_mul_f32 v[32:33], v[32:33], v[88:89]
    v_pk_mul_f32 v[34:35], v[34:35], v[90:91]
    v_pk_mul_f32 v[36:37], v[36:37], v[92:93]
    v_pk_mul_f32 v[38:39], v[38:39], v[94:95]
    v_exp_f32 v28, v28
    v_exp_f32 v29, v29
    v_exp_f32 v30, v30
    v_exp_f32 v31, v31
    v_exp_f32 v32, v32
    v_exp_f32 v33, v33
    v_exp_f32 v34, v34
    v_exp_f32 v35, v35
    v_exp_f32 v36, v36
    v_exp_f32 v37, v37
    v_exp_f32 v38, v38
    v_exp_f32 v39, v39
    v_pk_add_f32 v[28:29], v[28:29], 1.0 op_sel_hi:[1,0]
    v_pk_add_f32 v[30:31], v[30:31], 1.0 op_sel_hi:[1,0]
    v_pk_add_f32 v[32:33], v[32:33], 1.0 op_sel_hi:[1,0]
    v_pk_add_f32 v[34:35], v[34:35], 1.0 op_sel_hi:[1,0]
    v_pk_add_f32 v[36:37], v[36:37], 1.0 op_sel_hi:[1,0]
    v_pk_add_f32 v[38:39], v[38:39], 1.0 op_sel_hi:[1,0]
    v_rcp_f32 v28, v28
    v_rcp_f32 v29, v29
    v_rcp_f32 v30, v30
    v_rcp_f32 v31, v31
    v_rcp_f32 v32, v32
    v_rcp_f32 v33, v33
    v_rcp_f32 v34, v34
    v_rcp_f32 v35, v35
    v_rcp_f32 v36, v36
    v_rcp_f32 v37, v37
    v_rcp_f32 v38, v38
    v_rcp_f32 v39, v39
    v_pk_mul_f32 v[84:85], v[84:85], v[28:29]
    v_pk_mul_f32 v[86:87], v[86:87], v[30:31]
    v_pk_mul_f32 v[88:89], v[88:89], v[32:33]
    v_pk_mul_f32 v[90:91], v[90:91], v[34:35]
    v_pk_mul_f32 v[92:93], v[92:93], v[36:37]
    v_pk_mul_f32 v[94:95], v[94:95], v[38:39]
    v_cvt_pk_bf16_f32 v52, v84, v85
    v_cvt_pk_bf16_f32 v53, v86, v87
    v_cvt_pk_bf16_f32 v54, v88, v89
    v_cvt_pk_bf16_f32 v55, v90, v91
    v_cvt_pk_bf16_f32 v56, v92, v93
    v_cvt_pk_bf16_f32 v57, v94, v95
    v_lshlrev_b32 v28, 16, v52
    v_and_b32 v29, s25, v52
    v_lshlrev_b32 v30, 16, v53
    v_and_b32 v31, s25, v53
    v_lshlrev_b32 v32, 16, v54
    v_and_b32 v33, s25, v54
    v_lshlrev_b32 v34, 16, v55
    v_and_b32 v35, s25, v55
    v_lshlrev_b32 v36, 16, v56
    v_and_b32 v37, s25, v56
    v_lshlrev_b32 v38, 16, v57
    v_and_b32 v39, s25, v57
    v_pk_add_f32 v[58:59], v[58:59], v[28:29]
    v_pk_fma_f32 v[62:63], v[28:29], v[28:29], v[62:63]
    v_pk_add_f32 v[58:59], v[58:59], v[30:31]
    v_pk_fma_f32 v[62:63], v[30:31], v[30:31], v[62:63]
    v_pk_add_f32 v[60:61], v[60:61], v[32:33]
    v_pk_fma_f32 v[64:65], v[32:33], v[32:33], v[64:65]
    v_pk_add_f32 v[60:61], v[60:61], v[34:35]
    v_pk_fma_f32 v[64:65], v[34:35], v[34:35], v[64:65]
    v_pk_add_f32 v[58:59], v[58:59], v[36:37]
    v_pk_fma_f32 v[62:63], v[36:37], v[36:37], v[62:63]
    v_pk_add_f32 v[58:59], v[58:59], v[38:39]
    v_pk_fma_f32 v[62:63], v[38:39], v[38:39], v[62:63]
    v_add_f32 v58, v58, v59
    v_add_f32 v62, v62, v63
    v_add_f32 v60, v60, v61
    v_add_f32 v64, v64, v65
    v_mov_b32 v28, v58
    v_mov_b32 v29, v62
    v_mov_b32 v30, v60
    v_mov_b32 v31, v64
    v_permlane16_swap_b32 v58, v28
    v_permlane16_swap_b32 v62, v29
    v_permlane16_swap_b32 v60, v30
    v_permlane16_swap_b32 v64, v31
    v_add_f32 v58, v58, v28
    v_add_f32 v62, v62, v29
    v_add_f32 v60, v60, v30
    v_add_f32 v64, v64, v31
    v_mov_b32 v28, v58
    v_mov_b32 v29, v62
    v_mov_b32 v30, v60
    v_mov_b32 v31, v64
    v_permlane32_swap_b32 v58, v28
    v_permlane32_swap_b32 v62, v29
    v_permlane32_swap_b32 v60, v30
    v_permlane32_swap_b32 v64, v31
    v_add_f32 v58, v58, v28
    v_add_f32 v62, v62, v29
    v_add_f32 v60, v60, v30
    v_add_f32 v64, v64, v31
    v_cmp_eq_u32 vcc, 1, v1
    v_mov_b32 v12, 0x7fc00000
    s_lshl1_add_u32 s24, s21, s26
    v_cndmask_b32 v10, v58, v60, vcc
    v_cndmask_b32 v11, v62, v64, vcc
    v_cndmask_b32 v8, v3, v4, vcc
    v_cmp_eq_u32 vcc, -1, v10
    s_lshl_b32 s24, s24, 12
    s_nop 0
    v_cndmask_b32 v10, v10, v12, vcc
    v_cmp_eq_u32 vcc, -1, v11
    s_add_u32 s24, s24, 65536
    s_nop 0
    v_cndmask_b32 v11, v11, v12, vcc
    s_lshl1_add_u32 s25, s22, s27
    s_lshl_b32 s25, s25, 8
    s_add_u32 s25, s25, s24
    v_and_b32 v8, 31, v8
    v_lshl_add_u32 v8, v8, 3, s25
    s_mov_b32 exec_hi, 0
    global_store_dwordx2 v8, v[10:11], s[4:5] sc1
    s_mov_b32 exec_hi, -1
    ds_write_b64 v24, v[44:45] offset:0
    ds_write_b64 v25, v[46:47] offset:0
    ds_write_b64 v24, v[48:49] offset:32
    ds_write_b64 v25, v[50:51] offset:32
    ds_write_b64 v24, v[52:53] offset:64
    ds_write_b64 v25, v[54:55] offset:64
    ds_write_b64 v24, v[56:57] offset:96
    v_mov_b32 v68, 0
    v_mov_b32 v69, 0
    v_mov_b32 v70, 0
    v_mov_b32 v71, 0
    v_mov_b32 v72, 0
    v_mov_b32 v73, 0
    v_mov_b32 v74, 0
    v_mov_b32 v75, 0
    v_mov_b32 v76, 0
    v_mov_b32 v77, 0
    v_mov_b32 v78, 0
    v_mov_b32 v79, 0
    v_mov_b32 v80, 0
    v_mov_b32 v81, 0
    v_mov_b32 v82, 0
    v_mov_b32 v83, 0
    v_mov_b32 v84, 0
    v_mov_b32 v85, 0
    v_mov_b32 v86, 0
    v_mov_b32 v87, 0
    v_mov_b32 v88, 0
    v_mov_b32 v89, 0
    v_mov_b32 v90, 0
    v_mov_b32 v91, 0
    v_mov_b32 v92, 0
    v_mov_b32 v93, 0
    v_mov_b32 v94, 0
    v_mov_b32 v95, 0
adaLN_cond__spectral_fnet__mixer_gmlp__prompt_kernel_zcont:
    s_cmp_lt_u32 s43, 4
    s_cbranch_scc1 adaLN_cond__spectral_fnet__mixer_gmlp__prompt_kernel_zloop
    s_waitcnt lgkmcnt(0)
    v_mul_u32_u24 v16, 224, v3
    v_lshl_add_u32 v16, v1, 3, v16
    v_add_u32 v16, 145408, v16
    v_mul_u32_u24 v18, 224, v4
    v_lshl_add_u32 v18, v1, 3, v18
    v_add_u32 v18, 145408, v18
    v_add_u32 v17, 96, v16
    s_lshl_b32 s23, s27, 7
    v_add_u32 v16, s23, v16
    v_add_u32 v18, s23, v18
    v_pk_mul_f32 v[136:137], v[68:69], v[68:69]
    v_pk_mul_f32 v[138:139], v[70:71], v[70:71]
    v_pk_mul_f32 v[140:141], v[72:73], v[72:73]
    v_pk_mul_f32 v[142:143], v[74:75], v[74:75]
    v_pk_mul_f32 v[144:145], v[76:77], v[76:77]
    v_pk_mul_f32 v[146:147], v[78:79], v[78:79]
    v_pk_mul_f32 v[148:149], v[80:81], v[80:81]
    v_pk_mul_f32 v[150:151], v[82:83], v[82:83]
    v_pk_fma_f32 v[136:137], v[136:137], v[6:7], v[6:7] op_sel:[0,0,1] op_sel_hi:[1,0,1]
    v_pk_fma_f32 v[138:139], v[138:139], v[6:7], v[6:7] op_sel:[0,0,1] op_sel_hi:[1,0,1]
    v_pk_fma_f32 v[140:141], v[140:141], v[6:7], v[6:7] op_sel:[0,0,1] op_sel_hi:[1,0,1]
    v_pk_fma_f32 v[142:143], v[142:143], v[6:7], v[6:7] op_sel:[0,0,1] op_sel_hi:[1,0,1]
    v_pk_fma_f32 v[144:145], v[144:145], v[6:7], v[6:7] op_sel:[0,0,1] op_sel_hi:[1,0,1]
    v_pk_fma_f32 v[146:147], v[146:147], v[6:7], v[6:7] op_sel:[0,0,1] op_sel_hi:[1,0,1]
    v_pk_fma_f32 v[148:149], v[148:149], v[6:7], v[6:7] op_sel:[0,0,1] op_sel_hi:[1,0,1]
    v_pk_fma_f32 v[150:151], v[150:151], v[6:7], v[6:7] op_sel:[0,0,1] op_sel_hi:[1,0,1]
    v_pk_mul_f32 v[136:137], v[136:137], v[68:69]
    v_pk_mul_f32 v[138:139], v[138:139], v[70:71]
    v_pk_mul_f32 v[140:141], v[140:141], v[72:73]
    v_pk_mul_f32 v[142:143], v[142:143], v[74:75]
    v_pk_mul_f32 v[144:145], v[144:145], v[76:77]
    v_pk_mul_f32 v[146:147], v[146:147], v[78:79]
    v_pk_mul_f32 v[148:149], v[148:149], v[80:81]
    v_pk_mul_f32 v[150:151], v[150:151], v[82:83]
    v_exp_f32 v136, v136
    v_exp_f32 v137, v137
    v_exp_f32 v138, v138
    v_exp_f32 v139, v139
    v_exp_f32 v140, v140
    v_exp_f32 v141, v141
    v_exp_f32 v142, v142
    v_exp_f32 v143, v143
    v_exp_f32 v144, v144
    v_exp_f32 v145, v145
    v_exp_f32 v146, v146
    v_exp_f32 v147, v147
    v_exp_f32 v148, v148
    v_exp_f32 v149, v149
    v_exp_f32 v150, v150
    v_exp_f32 v151, v151
    v_pk_add_f32 v[136:137], v[136:137], 1.0 op_sel_hi:[1,0]
    v_pk_add_f32 v[138:139], v[138:139], 1.0 op_sel_hi:[1,0]
    v_pk_add_f32 v[140:141], v[140:141], 1.0 op_sel_hi:[1,0]
    v_pk_add_f32 v[142:143], v[142:143], 1.0 op_sel_hi:[1,0]
    v_pk_add_f32 v[144:145], v[144:145], 1.0 op_sel_hi:[1,0]
    v_pk_add_f32 v[146:147], v[146:147], 1.0 op_sel_hi:[1,0]
    v_pk_add_f32 v[148:149], v[148:149], 1.0 op_sel_hi:[1,0]
    v_pk_add_f32 v[150:151], v[150:151], 1.0 op_sel_hi:[1,0]
    v_rcp_f32 v136, v136
    v_rcp_f32 v137, v137
    v_rcp_f32 v138, v138
    v_rcp_f32 v139, v139
    v_rcp_f32 v140, v140
    v_rcp_f32 v141, v141
    v_rcp_f32 v142, v142
    v_rcp_f32 v143, v143
    v_rcp_f32 v144, v144
    v_rcp_f32 v145, v145
    v_rcp_f32 v146, v146
    v_rcp_f32 v147, v147
    v_rcp_f32 v148, v148
    v_rcp_f32 v149, v149
    v_rcp_f32 v150, v150
    v_rcp_f32 v151, v151
    v_pk_mul_f32 v[68:69], v[68:69], v[136:137]
    v_pk_mul_f32 v[70:71], v[70:71], v[138:139]
    v_pk_mul_f32 v[72:73], v[72:73], v[140:141]
    v_pk_mul_f32 v[74:75], v[74:75], v[142:143]
    v_pk_mul_f32 v[76:77], v[76:77], v[144:145]
    v_pk_mul_f32 v[78:79], v[78:79], v[146:147]
    v_pk_mul_f32 v[80:81], v[80:81], v[148:149]
    v_pk_mul_f32 v[82:83], v[82:83], v[150:151]
    v_cvt_pk_bf16_f32 v68, v68, v69
    v_cvt_pk_bf16_f32 v69, v70, v71
    ds_write_b64 v16, v[68:69] offset:0
    v_cvt_pk_bf16_f32 v72, v72, v73
    v_cvt_pk_bf16_f32 v73, v74, v75
    ds_write_b64 v18, v[72:73] offset:0
    v_cvt_pk_bf16_f32 v76, v76, v77
    v_cvt_pk_bf16_f32 v77, v78, v79
    ds_write_b64 v16, v[76:77] offset:32
    v_cvt_pk_bf16_f32 v80, v80, v81
    v_cvt_pk_bf16_f32 v81, v82, v83
    ds_write_b64 v18, v[80:81] offset:32
    v_pk_mul_f32 v[136:137], v[84:85], v[84:85]
    v_pk_mul_f32 v[138:139], v[86:87], v[86:87]
    v_pk_mul_f32 v[140:141], v[88:89], v[88:89]
    v_pk_mul_f32 v[142:143], v[90:91], v[90:91]
    v_pk_mul_f32 v[144:145], v[92:93], v[92:93]
    v_pk_mul_f32 v[146:147], v[94:95], v[94:95]
    v_pk_fma_f32 v[136:137], v[136:137], v[6:7], v[6:7] op_sel:[0,0,1] op_sel_hi:[1,0,1]
    v_pk_fma_f32 v[138:139], v[138:139], v[6:7], v[6:7] op_sel:[0,0,1] op_sel_hi:[1,0,1]
    v_pk_fma_f32 v[140:141], v[140:141], v[6:7], v[6:7] op_sel:[0,0,1] op_sel_hi:[1,0,1]
    v_pk_fma_f32 v[142:143], v[142:143], v[6:7], v[6:7] op_sel:[0,0,1] op_sel_hi:[1,0,1]
    v_pk_fma_f32 v[144:145], v[144:145], v[6:7], v[6:7] op_sel:[0,0,1] op_sel_hi:[1,0,1]
    v_pk_fma_f32 v[146:147], v[146:147], v[6:7], v[6:7] op_sel:[0,0,1] op_sel_hi:[1,0,1]
    v_pk_mul_f32 v[136:137], v[136:137], v[84:85]
    v_pk_mul_f32 v[138:139], v[138:139], v[86:87]
    v_pk_mul_f32 v[140:141], v[140:141], v[88:89]
    v_pk_mul_f32 v[142:143], v[142:143], v[90:91]
    v_pk_mul_f32 v[144:145], v[144:145], v[92:93]
    v_pk_mul_f32 v[146:147], v[146:147], v[94:95]
    v_exp_f32 v136, v136
    v_exp_f32 v137, v137
    v_exp_f32 v138, v138
    v_exp_f32 v139, v139
    v_exp_f32 v140, v140
    v_exp_f32 v141, v141
    v_exp_f32 v142, v142
    v_exp_f32 v143, v143
    v_exp_f32 v144, v144
    v_exp_f32 v145, v145
    v_exp_f32 v146, v146
    v_exp_f32 v147, v147
    v_pk_add_f32 v[136:137], v[136:137], 1.0 op_sel_hi:[1,0]
    v_pk_add_f32 v[138:139], v[138:139], 1.0 op_sel_hi:[1,0]
    v_pk_add_f32 v[140:141], v[140:141], 1.0 op_sel_hi:[1,0]
    v_pk_add_f32 v[142:143], v[142:143], 1.0 op_sel_hi:[1,0]
    v_pk_add_f32 v[144:145], v[144:145], 1.0 op_sel_hi:[1,0]
    v_pk_add_f32 v[146:147], v[146:147], 1.0 op_sel_hi:[1,0]
    v_rcp_f32 v136, v136
    v_rcp_f32 v137, v137
    v_rcp_f32 v138, v138
    v_rcp_f32 v139, v139
    v_rcp_f32 v140, v140
    v_rcp_f32 v141, v141
    v_rcp_f32 v142, v142
    v_rcp_f32 v143, v143
    v_rcp_f32 v144, v144
    v_rcp_f32 v145, v145
    v_rcp_f32 v146, v146
    v_rcp_f32 v147, v147
    v_pk_mul_f32 v[84:85], v[84:85], v[136:137]
    v_pk_mul_f32 v[86:87], v[86:87], v[138:139]
    v_pk_mul_f32 v[88:89], v[88:89], v[140:141]
    v_pk_mul_f32 v[90:91], v[90:91], v[142:143]
    v_pk_mul_f32 v[92:93], v[92:93], v[144:145]
    v_pk_mul_f32 v[94:95], v[94:95], v[146:147]
    v_cvt_pk_bf16_f32 v84, v84, v85
    v_cvt_pk_bf16_f32 v85, v86, v87
    ds_write_b64 v16, v[84:85] offset:64
    v_cvt_pk_bf16_f32 v88, v88, v89
    v_cvt_pk_bf16_f32 v89, v90, v91
    ds_write_b64 v18, v[88:89] offset:64
    v_cvt_pk_bf16_f32 v92, v92, v93
    v_cvt_pk_bf16_f32 v93, v94, v95
    ds_write_b64 v17, v[92:93]
    s_waitcnt lgkmcnt(0)
    v_lshl_add_u32 v149, s20, 4, v2
    v_lshl_add_u32 v12, s21, 6, v149
    v_lshlrev_b32 v12, 1, v12
    global_load_ushort v148, v12, s[36:37]
    s_and_b32 s23, s20, 1
    s_lshl_b32 s23, s23, 2
    v_add_u32 v16, s23, v1
    v_and_b32 v14, 7, v2
    v_xor_b32 v13, v16, v14
    v_lshlrev_b32 v13, 4, v13
    v_lshl_add_u32 v5, v2, 7, v13
    v_add_u32 v13, 14336, v13
    v_lshl_add_u32 v6, v149, 7, v13
    v_xor_b32 v15, 16, v149
    v_lshl_add_u32 v7, v15, 7, v13
    v_and_b32 v12, 63, v0
    s_mul_i32 s23, s20, 7168
    s_add_u32 s23, s23, 114688
    v_lshl_add_u32 v156, v12, 4, s23
    s_xor_b32 s24, s20, 1
    s_mul_i32 s24, s24, 7168
    s_add_u32 s24, s24, 114688
    v_lshl_add_u32 v157, v12, 4, s24
    v_mul_u32_u24 v158, 224, v149
    v_lshl_add_u32 v158, v1, 3, v158
    v_add_u32 v158, 145408, v158
    v_add_u32 v16, 0, v12
    v_mul_u32_u24 v17, 4682, v16
    v_lshrrev_b32 v17, 16, v17
    v_mul_u32_u24 v19, 14, v17
    v_sub_u32 v18, v16, v19
    v_mul_u32_u24 v17, 1792, v17
    v_lshl_add_u32 v160, v18, 4, v17
    v_add_u32 v16, 64, v12
    v_mul_u32_u24 v17, 4682, v16
    v_lshrrev_b32 v17, 16, v17
    v_mul_u32_u24 v19, 14, v17
    v_sub_u32 v18, v16, v19
    v_mul_u32_u24 v17, 1792, v17
    v_lshl_add_u32 v161, v18, 4, v17
    v_add_u32 v16, 128, v12
    v_mul_u32_u24 v17, 4682, v16
    v_lshrrev_b32 v17, 16, v17
    v_mul_u32_u24 v19, 14, v17
    v_sub_u32 v18, v16, v19
    v_mul_u32_u24 v17, 1792, v17
    v_lshl_add_u32 v162, v18, 4, v17
    v_add_u32 v16, 192, v12
    v_mul_u32_u24 v17, 4682, v16
    v_lshrrev_b32 v17, 16, v17
    v_mul_u32_u24 v19, 14, v17
    v_sub_u32 v18, v16, v19
    v_mul_u32_u24 v17, 1792, v17
    v_lshl_add_u32 v163, v18, 4, v17
    s_lshl2_add_u32 s23, s21, s20
    s_mul_i32 s23, s23, 28672
    s_mul_i32 s24, s22, 224
    s_add_u32 s23, s23, s24
    s_add_u32 s23, s23, 25165824
    v_add_u32 v160, s23, v160
    v_add_u32 v161, s23, v161
    v_add_u32 v162, s23, v162
    v_add_u32 v163, s23, v163
    s_mul_i32 s23, s20, 3584
    s_add_u32 s23, s23, 145408
    v_lshl_add_u32 v164, v12, 4, s23
    s_mov_b32 s34, 0
    s_mov_b32 s35, 0
    s_waitcnt vmcnt(0)
    v_lshlrev_b32 v152, 16, v148
    v_lshlrev_b32 v153, 16, v148
    v_lshlrev_b32 v154, 16, v148
    v_lshlrev_b32 v155, 16, v148
    s_barrier
    s_barrier
    ds_read_b128 v[132:135], v6
    ds_read_b128 v[136:139], v7
    ds_read_b128 v[76:79], v5 offset:0
    ds_read_b128 v[80:83], v5 offset:2048
    ds_read_b128 v[84:87], v5 offset:4096
    ds_read_b128 v[88:91], v5 offset:6144
    ds_read_b128 v[92:95], v5 offset:8192
    ds_read_b128 v[96:99], v5 offset:10240
    ds_read_b128 v[100:103], v5 offset:12288
    s_add_u32 s34, s34, 22528
    s_cmp_ge_u32 s34, 112640
    s_cselect_b32 s34, 0, s34
    v_add_u32 v8, s34, v5
    v_add_u32 v9, s34, v6
    v_add_u32 v10, s34, v7
    s_waitcnt lgkmcnt(0)
    s_barrier
    v_mfma_f32_16x16x32_bf16 v[20:23], v[76:79], v[132:135], v[152:155]
    ds_read_b128 v[140:143], v9
    ds_read_b128 v[144:147], v10
    v_mfma_f32_16x16x32_bf16 v[24:27], v[76:79], v[136:139], 0
    ds_read_b128 v[104:107], v8 offset:0
    ds_read_b128 v[108:111], v8 offset:2048
    v_mfma_f32_16x16x32_bf16 v[28:31], v[80:83], v[132:135], v[152:155]
    ds_read_b128 v[112:115], v8 offset:4096
    ds_read_b128 v[116:119], v8 offset:6144
    v_mfma_f32_16x16x32_bf16 v[32:35], v[80:83], v[136:139], 0
    ds_read_b128 v[120:123], v8 offset:8192
    ds_read_b128 v[124:127], v8 offset:10240
    v_mfma_f32_16x16x32_bf16 v[36:39], v[84:87], v[132:135], v[152:155]
    ds_read_b128 v[128:131], v8 offset:12288
    v_mfma_f32_16x16x32_bf16 v[40:43], v[84:87], v[136:139], 0
    v_mfma_f32_16x16x32_bf16 v[44:47], v[88:91], v[132:135], v[152:155]
    v_mfma_f32_16x16x32_bf16 v[48:51], v[88:91], v[136:139], 0
    v_mfma_f32_16x16x32_bf16 v[52:55], v[92:95], v[132:135], v[152:155]
    v_mfma_f32_16x16x32_bf16 v[56:59], v[92:95], v[136:139], 0
    v_mfma_f32_16x16x32_bf16 v[60:63], v[96:99], v[132:135], v[152:155]
    v_mfma_f32_16x16x32_bf16 v[64:67], v[96:99], v[136:139], 0
    v_mfma_f32_16x16x32_bf16 v[68:71], v[100:103], v[132:135], v[152:155]
    v_mfma_f32_16x16x32_bf16 v[72:75], v[100:103], v[136:139], 0
adaLN_cond__spectral_fnet__mixer_gmlp__prompt_kernel_gloop:
    s_add_u32 s34, s34, 22528
    s_cmp_ge_u32 s34, 112640
    s_cselect_b32 s34, 0, s34
    v_add_u32 v8, s34, v5
    v_add_u32 v9, s34, v6
    v_add_u32 v10, s34, v7
    s_waitcnt lgkmcnt(0)
    s_barrier
    v_mfma_f32_16x16x32_bf16 v[20:23], v[104:107], v[140:143], v[20:23]
    ds_read_b128 v[132:135], v9
    ds_read_b128 v[136:139], v10
    v_mfma_f32_16x16x32_bf16 v[24:27], v[104:107], v[144:147], v[24:27]
    ds_read_b128 v[76:79], v8 offset:0
    ds_read_b128 v[80:83], v8 offset:2048
    v_mfma_f32_16x16x32_bf16 v[28:31], v[108:111], v[140:143], v[28:31]
    ds_read_b128 v[84:87], v8 offset:4096
    ds_read_b128 v[88:91], v8 offset:6144
    v_mfma_f32_16x16x32_bf16 v[32:35], v[108:111], v[144:147], v[32:35]
    ds_read_b128 v[92:95], v8 offset:8192
    ds_read_b128 v[96:99], v8 offset:10240
    v_mfma_f32_16x16x32_bf16 v[36:39], v[112:115], v[140:143], v[36:39]
    ds_read_b128 v[100:103], v8 offset:12288
    v_mfma_f32_16x16x32_bf16 v[40:43], v[112:115], v[144:147], v[40:43]
    v_mfma_f32_16x16x32_bf16 v[44:47], v[116:119], v[140:143], v[44:47]
    v_mfma_f32_16x16x32_bf16 v[48:51], v[116:119], v[144:147], v[48:51]
    v_mfma_f32_16x16x32_bf16 v[52:55], v[120:123], v[140:143], v[52:55]
    v_mfma_f32_16x16x32_bf16 v[56:59], v[120:123], v[144:147], v[56:59]
    v_mfma_f32_16x16x32_bf16 v[60:63], v[124:127], v[140:143], v[60:63]
    v_mfma_f32_16x16x32_bf16 v[64:67], v[124:127], v[144:147], v[64:67]
    v_mfma_f32_16x16x32_bf16 v[68:71], v[128:131], v[140:143], v[68:71]
    v_mfma_f32_16x16x32_bf16 v[72:75], v[128:131], v[144:147], v[72:75]
    s_add_u32 s34, s34, 22528
    s_cmp_ge_u32 s34, 112640
    s_cselect_b32 s34, 0, s34
    v_add_u32 v8, s34, v5
    v_add_u32 v9, s34, v6
    v_add_u32 v10, s34, v7
    s_waitcnt lgkmcnt(0)
    s_barrier
    v_mfma_f32_16x16x32_bf16 v[20:23], v[76:79], v[132:135], v[20:23]
    ds_read_b128 v[140:143], v9
    ds_read_b128 v[144:147], v10
    v_mfma_f32_16x16x32_bf16 v[24:27], v[76:79], v[136:139], v[24:27]
    ds_read_b128 v[104:107], v8 offset:0
    ds_read_b128 v[108:111], v8 offset:2048
    v_mfma_f32_16x16x32_bf16 v[28:31], v[80:83], v[132:135], v[28:31]
    ds_read_b128 v[112:115], v8 offset:4096
    ds_read_b128 v[116:119], v8 offset:6144
    v_mfma_f32_16x16x32_bf16 v[32:35], v[80:83], v[136:139], v[32:35]
    ds_read_b128 v[120:123], v8 offset:8192
    ds_read_b128 v[124:127], v8 offset:10240
    v_mfma_f32_16x16x32_bf16 v[36:39], v[84:87], v[132:135], v[36:39]
    ds_read_b128 v[128:131], v8 offset:12288
    v_mfma_f32_16x16x32_bf16 v[40:43], v[84:87], v[136:139], v[40:43]
    v_mfma_f32_16x16x32_bf16 v[44:47], v[88:91], v[132:135], v[44:47]
    v_mfma_f32_16x16x32_bf16 v[48:51], v[88:91], v[136:139], v[48:51]
    v_mfma_f32_16x16x32_bf16 v[52:55], v[92:95], v[132:135], v[52:55]
    v_mfma_f32_16x16x32_bf16 v[56:59], v[92:95], v[136:139], v[56:59]
    v_mfma_f32_16x16x32_bf16 v[60:63], v[96:99], v[132:135], v[60:63]
    v_mfma_f32_16x16x32_bf16 v[64:67], v[96:99], v[136:139], v[64:67]
    v_mfma_f32_16x16x32_bf16 v[68:71], v[100:103], v[132:135], v[68:71]
    v_mfma_f32_16x16x32_bf16 v[72:75], v[100:103], v[136:139], v[72:75]
    s_add_u32 s35, s35, 1
    s_cmp_lt_u32 s35, 15
    s_cbranch_scc1 adaLN_cond__spectral_fnet__mixer_gmlp__prompt_kernel_gloop
    s_waitcnt lgkmcnt(0)
    v_mfma_f32_16x16x32_bf16 v[20:23], v[104:107], v[140:143], v[20:23]
    v_mfma_f32_16x16x32_bf16 v[24:27], v[104:107], v[144:147], v[24:27]
    v_mfma_f32_16x16x32_bf16 v[28:31], v[108:111], v[140:143], v[28:31]
    v_mfma_f32_16x16x32_bf16 v[32:35], v[108:111], v[144:147], v[32:35]
    v_mfma_f32_16x16x32_bf16 v[36:39], v[112:115], v[140:143], v[36:39]
    v_mfma_f32_16x16x32_bf16 v[40:43], v[112:115], v[144:147], v[40:43]
    v_mfma_f32_16x16x32_bf16 v[44:47], v[116:119], v[140:143], v[44:47]
    v_mfma_f32_16x16x32_bf16 v[48:51], v[116:119], v[144:147], v[48:51]
    v_mfma_f32_16x16x32_bf16 v[52:55], v[120:123], v[140:143], v[52:55]
    v_mfma_f32_16x16x32_bf16 v[56:59], v[120:123], v[144:147], v[56:59]
    v_mfma_f32_16x16x32_bf16 v[60:63], v[124:127], v[140:143], v[60:63]
    v_mfma_f32_16x16x32_bf16 v[64:67], v[124:127], v[144:147], v[64:67]
    v_mfma_f32_16x16x32_bf16 v[68:71], v[128:131], v[140:143], v[68:71]
    v_mfma_f32_16x16x32_bf16 v[72:75], v[128:131], v[144:147], v[72:75]
    ds_write_b128 v156, v[24:27] offset:0
    ds_write_b128 v156, v[32:35] offset:1024
    ds_write_b128 v156, v[40:43] offset:2048
    ds_write_b128 v156, v[48:51] offset:3072
    ds_write_b128 v156, v[56:59] offset:4096
    s_nop 0
    ds_write_b128 v156, v[64:67] offset:5120
    s_nop 0
    ds_write_b128 v156, v[72:75] offset:6144
    s_waitcnt vmcnt(0) lgkmcnt(0)
    v_lshlrev_b32 v148, 16, v148
    s_barrier
    ds_read_b128 v[76:79], v157 offset:0
    ds_read_b128 v[80:83], v157 offset:1024
    ds_read_b128 v[84:87], v157 offset:2048
    ds_read_b128 v[88:91], v157 offset:3072
    ds_read_b128 v[92:95], v157 offset:4096
    ds_read_b128 v[96:99], v157 offset:5120
    ds_read_b128 v[100:103], v157 offset:6144
    ds_read_b64 v[104:105], v158 offset:0
    ds_read_b64 v[108:109], v158 offset:32
    ds_read_b64 v[112:113], v158 offset:64
    ds_read_b64 v[116:117], v158 offset:96
    ds_read_b64 v[120:121], v158 offset:128
    ds_read_b64 v[124:125], v158 offset:160
    ds_read_b64 v[128:129], v158 offset:192
    v_mov_b32 v140, v148
    v_mov_b32 v141, v148
    s_mov_b32 s33, 0xffff0000
    s_waitcnt lgkmcnt(13)
    v_pk_add_f32 v[20:21], v[20:21], v[76:77]
    v_pk_add_f32 v[22:23], v[22:23], v[78:79]
    s_waitcnt lgkmcnt(12)
    v_pk_add_f32 v[28:29], v[28:29], v[80:81]
    v_pk_add_f32 v[30:31], v[30:31], v[82:83]
    s_waitcnt lgkmcnt(11)
    v_pk_add_f32 v[36:37], v[36:37], v[84:85]
    v_pk_add_f32 v[38:39], v[38:39], v[86:87]
    s_waitcnt lgkmcnt(10)
    v_pk_add_f32 v[44:45], v[44:45], v[88:89]
    v_pk_add_f32 v[46:47], v[46:47], v[90:91]
    s_waitcnt lgkmcnt(9)
    v_pk_add_f32 v[52:53], v[52:53], v[92:93]
    v_pk_add_f32 v[54:55], v[54:55], v[94:95]
    s_waitcnt lgkmcnt(8)
    v_pk_add_f32 v[60:61], v[60:61], v[96:97]
    v_pk_add_f32 v[62:63], v[62:63], v[98:99]
    s_waitcnt lgkmcnt(7)
    v_pk_add_f32 v[68:69], v[68:69], v[100:101]
    v_pk_add_f32 v[70:71], v[70:71], v[102:103]
    s_waitcnt lgkmcnt(6)
    v_lshlrev_b32 v106, 16, v104
    v_and_b32 v107, s33, v104
    v_pk_mul_f32 v[20:21], v[20:21], v[106:107]
    v_cvt_pk_bf16_f32 v76, v20, v21
    v_lshlrev_b32 v106, 16, v105
    v_and_b32 v107, s33, v105
    v_pk_mul_f32 v[22:23], v[22:23], v[106:107]
    v_cvt_pk_bf16_f32 v77, v22, v23
    ds_write_b64 v158, v[76:77] offset:0
    s_waitcnt lgkmcnt(5)
    v_lshlrev_b32 v110, 16, v108
    v_and_b32 v111, s33, v108
    v_pk_mul_f32 v[28:29], v[28:29], v[110:111]
    v_cvt_pk_bf16_f32 v80, v28, v29
    v_lshlrev_b32 v110, 16, v109
    v_and_b32 v111, s33, v109
    v_pk_mul_f32 v[30:31], v[30:31], v[110:111]
    v_cvt_pk_bf16_f32 v81, v30, v31
    ds_write_b64 v158, v[80:81] offset:32
    s_waitcnt lgkmcnt(4)
    v_lshlrev_b32 v114, 16, v112
    v_and_b32 v115, s33, v112
    v_pk_mul_f32 v[36:37], v[36:37], v[114:115]
    v_cvt_pk_bf16_f32 v84, v36, v37
    v_lshlrev_b32 v114, 16, v113
    v_and_b32 v115, s33, v113
    v_pk_mul_f32 v[38:39], v[38:39], v[114:115]
    v_cvt_pk_bf16_f32 v85, v38, v39
    ds_write_b64 v158, v[84:85] offset:64
    s_waitcnt lgkmcnt(3)
    v_lshlrev_b32 v118, 16, v116
    v_and_b32 v119, s33, v116
    v_pk_mul_f32 v[44:45], v[44:45], v[118:119]
    v_cvt_pk_bf16_f32 v88, v44, v45
    v_lshlrev_b32 v118, 16, v117
    v_and_b32 v119, s33, v117
    v_pk_mul_f32 v[46:47], v[46:47], v[118:119]
    v_cvt_pk_bf16_f32 v89, v46, v47
    ds_write_b64 v158, v[88:89] offset:96
    s_waitcnt lgkmcnt(2)
    v_lshlrev_b32 v122, 16, v120
    v_and_b32 v123, s33, v120
    v_pk_mul_f32 v[52:53], v[52:53], v[122:123]
    v_cvt_pk_bf16_f32 v92, v52, v53
    v_lshlrev_b32 v122, 16, v121
    v_and_b32 v123, s33, v121
    v_pk_mul_f32 v[54:55], v[54:55], v[122:123]
    v_cvt_pk_bf16_f32 v93, v54, v55
    ds_write_b64 v158, v[92:93] offset:128
    s_waitcnt lgkmcnt(1)
    v_lshlrev_b32 v126, 16, v124
    v_and_b32 v127, s33, v124
    v_pk_mul_f32 v[60:61], v[60:61], v[126:127]
    v_cvt_pk_bf16_f32 v96, v60, v61
    v_lshlrev_b32 v126, 16, v125
    v_and_b32 v127, s33, v125
    v_pk_mul_f32 v[62:63], v[62:63], v[126:127]
    v_cvt_pk_bf16_f32 v97, v62, v63
    ds_write_b64 v158, v[96:97] offset:160
    s_waitcnt lgkmcnt(0)
    v_lshlrev_b32 v130, 16, v128
    v_and_b32 v131, s33, v128
    v_pk_mul_f32 v[68:69], v[68:69], v[130:131]
    v_cvt_pk_bf16_f32 v100, v68, v69
    v_lshlrev_b32 v130, 16, v129
    v_and_b32 v131, s33, v129
    v_pk_mul_f32 v[70:71], v[70:71], v[130:131]
    v_cvt_pk_bf16_f32 v101, v70, v71
    ds_write_b64 v158, v[100:101] offset:192
    s_waitcnt lgkmcnt(0)
    ds_read_b128 v[104:107], v164 offset:0
    ds_read_b128 v[108:111], v164 offset:1024
    ds_read_b128 v[112:115], v164 offset:2048
    ds_read_b128 v[116:119], v164 offset:3072
    s_waitcnt lgkmcnt(3)
    global_store_dwordx4 v160, v[104:107], s[4:5] sc1
    s_waitcnt lgkmcnt(2)
    global_store_dwordx4 v161, v[108:111], s[4:5] sc1
    s_waitcnt lgkmcnt(1)
    global_store_dwordx4 v162, v[112:115], s[4:5] sc1
    s_waitcnt lgkmcnt(0)
    s_mov_b32 exec_hi, 0
    global_store_dwordx4 v163, v[116:119], s[4:5] sc1
    s_mov_b32 exec_hi, -1
    s_lshl3_add_u32 s23, s21, s22
    s_lshl_b32 s23, s23, 7
    s_add_u32 s23, s23, 413696
    v_mov_b32 v250, 159748
    v_mov_b32 v251, 1
    s_waitcnt vmcnt(0)
    s_mov_b64 exec, 1
    ds_add_rtn_u32 v250, v250, v251
    s_waitcnt lgkmcnt(0)
    v_readfirstlane_b32 s24, v250
    v_mov_b32 v250, s23
    v_mov_b32 v251, s64
    s_cmp_lg_u32 s24, 3
    s_cbranch_scc1 adaLN_cond__spectral_fnet__mixer_gmlp__prompt_kernel_noflp
    global_store_dword v250, v251, s[4:5] sc1
adaLN_cond__spectral_fnet__mixer_gmlp__prompt_kernel_noflp:
    s_mov_b64 exec, -1
    s_barrier
    v_lshl_add_u32 v5, s20, 4, v2
    s_and_b32 s25, s20, 1
    v_lshrrev_b32 v8, 2, v2
    v_lshl_add_u32 v8, v1, 3, v8
    v_lshlrev_b32 v8, 7, v8
    v_and_b32 v9, 1, v2
    v_lshl_add_u32 v8, v9, 3, v8
    s_lshl_b32 s23, s25, 13
    v_add_u32 v8, s23, v8
    v_bfe_u32 v9, v2, 3, 1
    v_and_b32 v10, 1, v1
    v_lshl_or_b32 v9, v10, 1, v9
    v_lshlrev_b32 v9, 1, v9
    v_bfe_u32 v10, v2, 1, 1
    v_xor_b32 v9, v9, v10
    v_xor_b32 v11, 0, v9
    v_lshl_add_u32 v16, v11, 4, v8
    v_add_u32 v20, 65536, v16
    v_xor_b32 v11, 2, v9
    v_lshl_add_u32 v17, v11, 4, v8
    v_add_u32 v21, 65536, v17
    v_xor_b32 v11, 4, v9
    v_lshl_add_u32 v18, v11, 4, v8
    v_add_u32 v22, 65536, v18
    v_xor_b32 v11, 6, v9
    v_lshl_add_u32 v19, v11, 4, v8
    v_add_u32 v23, 65536, v19
    v_and_b32 v8, 7, v2
    v_xor_b32 v9, v1, v8
    v_lshlrev_b32 v9, 4, v9
    s_add_u32 s23, s23, 81920
    v_add_u32 v9, s23, v9
    v_lshl_add_u32 v24, v5, 7, v9
    v_xor_b32 v26, 2048, v24
    v_xor_b32 v25, 64, v24
    v_xor_b32 v27, 64, v26
    v_add_u32 v28, 65536, v24
    v_add_u32 v29, 65536, v25
    v_add_u32 v30, 65536, v26
    v_add_u32 v31, 65536, v27
    s_lshl_b32 s23, s22, 8
    s_add_u32 s23, s23, 10240
    v_lshl_add_u32 v8, v1, 4, s23
    global_load_dwordx4 v[160:163], v8, s[4:5] offset:0 sc1
    global_load_dwordx4 v[164:167], v8, s[4:5] offset:64 sc1
    global_load_dwordx4 v[168:171], v8, s[4:5] offset:128 sc1
    global_load_dwordx4 v[172:175], v8, s[4:5] offset:192 sc1
    s_barrier
    ds_read_b128 v[128:131], v24 offset:0
    ds_read_b128 v[132:135], v26 offset:0
    ds_read_b64_tr_b16 v[64:65], v16 offset:0
    ds_read_b64_tr_b16 v[66:67], v16 offset:512
    ds_read_b64_tr_b16 v[68:69], v17 offset:0
    ds_read_b64_tr_b16 v[70:71], v17 offset:512
    ds_read_b64_tr_b16 v[72:73], v18 offset:0
    ds_read_b64_tr_b16 v[74:75], v18 offset:512
    ds_read_b64_tr_b16 v[76:77], v19 offset:0
    ds_read_b64_tr_b16 v[78:79], v19 offset:512
    ds_read_b128 v[136:139], v25 offset:0
    ds_read_b128 v[140:143], v27 offset:0
    ds_read_b64_tr_b16 v[80:81], v16 offset:4096
    ds_read_b64_tr_b16 v[82:83], v16 offset:4608
    ds_read_b64_tr_b16 v[84:85], v17 offset:4096
    ds_read_b64_tr_b16 v[86:87], v17 offset:4608
    ds_read_b64_tr_b16 v[88:89], v18 offset:4096
    ds_read_b64_tr_b16 v[90:91], v18 offset:4608
    ds_read_b64_tr_b16 v[92:93], v19 offset:4096
    ds_read_b64_tr_b16 v[94:95], v19 offset:4608
    s_waitcnt lgkmcnt(0)
    s_barrier
    v_mfma_f32_16x16x32_bf16 v[32:35], v[64:67], v[128:131], 0
    ds_read_b128 v[144:147], v24 offset:16384
    ds_read_b128 v[148:151], v26 offset:16384
    v_mfma_f32_16x16x32_bf16 v[36:39], v[64:67], v[132:135], 0
    ds_read_b64_tr_b16 v[96:97], v16 offset:16384
    ds_read_b64_tr_b16 v[98:99], v16 offset:16896
    v_mfma_f32_16x16x32_bf16 v[40:43], v[68:71], v[128:131], 0
    ds_read_b64_tr_b16 v[100:101], v17 offset:16384
    ds_read_b64_tr_b16 v[102:103], v17 offset:16896
    v_mfma_f32_16x16x32_bf16 v[44:47], v[68:71], v[132:135], 0
    ds_read_b64_tr_b16 v[104:105], v18 offset:16384
    ds_read_b64_tr_b16 v[106:107], v18 offset:16896
    v_mfma_f32_16x16x32_bf16 v[48:51], v[72:75], v[128:131], 0
    ds_read_b64_tr_b16 v[108:109], v19 offset:16384
    ds_read_b64_tr_b16 v[110:111], v19 offset:16896
    v_mfma_f32_16x16x32_bf16 v[52:55], v[72:75], v[132:135], 0
    ds_read_b128 v[152:155], v25 offset:16384
    ds_read_b128 v[156:159], v27 offset:16384
    v_mfma_f32_16x16x32_bf16 v[56:59], v[76:79], v[128:131], 0
    ds_read_b64_tr_b16 v[112:113], v16 offset:20480
    ds_read_b64_tr_b16 v[114:115], v16 offset:20992
    v_mfma_f32_16x16x32_bf16 v[60:63], v[76:79], v[132:135], 0
    ds_read_b64_tr_b16 v[116:117], v17 offset:20480
    ds_read_b64_tr_b16 v[118:119], v17 offset:20992
    v_mfma_f32_16x16x32_bf16 v[32:35], v[80:83], v[136:139], v[32:35]
    ds_read_b64_tr_b16 v[120:121], v18 offset:20480
    ds_read_b64_tr_b16 v[122:123], v18 offset:20992
    v_mfma_f32_16x16x32_bf16 v[36:39], v[80:83], v[140:143], v[36:39]
    ds_read_b64_tr_b16 v[124:125], v19 offset:20480
    ds_read_b64_tr_b16 v[126:127], v19 offset:20992
    v_mfma_f32_16x16x32_bf16 v[40:43], v[84:87], v[136:139], v[40:43]
    v_mfma_f32_16x16x32_bf16 v[44:47], v[84:87], v[140:143], v[44:47]
    v_mfma_f32_16x16x32_bf16 v[48:51], v[88:91], v[136:139], v[48:51]
    v_mfma_f32_16x16x32_bf16 v[52:55], v[88:91], v[140:143], v[52:55]
    v_mfma_f32_16x16x32_bf16 v[56:59], v[92:95], v[136:139], v[56:59]
    v_mfma_f32_16x16x32_bf16 v[60:63], v[92:95], v[140:143], v[60:63]
    s_waitcnt lgkmcnt(0)
    s_barrier
    v_mfma_f32_16x16x32_bf16 v[32:35], v[96:99], v[144:147], v[32:35]
    ds_read_b128 v[128:131], v24 offset:32768
    ds_read_b128 v[132:135], v26 offset:32768
    v_mfma_f32_16x16x32_bf16 v[36:39], v[96:99], v[148:151], v[36:39]
    ds_read_b64_tr_b16 v[64:65], v16 offset:32768
    ds_read_b64_tr_b16 v[66:67], v16 offset:33280
    v_mfma_f32_16x16x32_bf16 v[40:43], v[100:103], v[144:147], v[40:43]
    ds_read_b64_tr_b16 v[68:69], v17 offset:32768
    ds_read_b64_tr_b16 v[70:71], v17 offset:33280
    v_mfma_f32_16x16x32_bf16 v[44:47], v[100:103], v[148:151], v[44:47]
    ds_read_b64_tr_b16 v[72:73], v18 offset:32768
    ds_read_b64_tr_b16 v[74:75], v18 offset:33280
    v_mfma_f32_16x16x32_bf16 v[48:51], v[104:107], v[144:147], v[48:51]
    ds_read_b64_tr_b16 v[76:77], v19 offset:32768
    ds_read_b64_tr_b16 v[78:79], v19 offset:33280
    v_mfma_f32_16x16x32_bf16 v[52:55], v[104:107], v[148:151], v[52:55]
    ds_read_b128 v[136:139], v25 offset:32768
    ds_read_b128 v[140:143], v27 offset:32768
    v_mfma_f32_16x16x32_bf16 v[56:59], v[108:111], v[144:147], v[56:59]
    ds_read_b64_tr_b16 v[80:81], v16 offset:36864
    ds_read_b64_tr_b16 v[82:83], v16 offset:37376
    v_mfma_f32_16x16x32_bf16 v[60:63], v[108:111], v[148:151], v[60:63]
    ds_read_b64_tr_b16 v[84:85], v17 offset:36864
    ds_read_b64_tr_b16 v[86:87], v17 offset:37376
    v_mfma_f32_16x16x32_bf16 v[32:35], v[112:115], v[152:155], v[32:35]
    ds_read_b64_tr_b16 v[88:89], v18 offset:36864
    ds_read_b64_tr_b16 v[90:91], v18 offset:37376
    v_mfma_f32_16x16x32_bf16 v[36:39], v[112:115], v[156:159], v[36:39]
    ds_read_b64_tr_b16 v[92:93], v19 offset:36864
    ds_read_b64_tr_b16 v[94:95], v19 offset:37376
    v_mfma_f32_16x16x32_bf16 v[40:43], v[116:119], v[152:155], v[40:43]
    v_mfma_f32_16x16x32_bf16 v[44:47], v[116:119], v[156:159], v[44:47]
    v_mfma_f32_16x16x32_bf16 v[48:51], v[120:123], v[152:155], v[48:51]
    v_mfma_f32_16x16x32_bf16 v[52:55], v[120:123], v[156:159], v[52:55]
    v_mfma_f32_16x16x32_bf16 v[56:59], v[124:127], v[152:155], v[56:59]
    v_mfma_f32_16x16x32_bf16 v[60:63], v[124:127], v[156:159], v[60:63]
    s_waitcnt lgkmcnt(0)
    s_barrier
    v_mfma_f32_16x16x32_bf16 v[32:35], v[64:67], v[128:131], v[32:35]
    ds_read_b128 v[144:147], v24 offset:49152
    ds_read_b128 v[148:151], v26 offset:49152
    v_mfma_f32_16x16x32_bf16 v[36:39], v[64:67], v[132:135], v[36:39]
    ds_read_b64_tr_b16 v[96:97], v16 offset:49152
    ds_read_b64_tr_b16 v[98:99], v16 offset:49664
    v_mfma_f32_16x16x32_bf16 v[40:43], v[68:71], v[128:131], v[40:43]
    ds_read_b64_tr_b16 v[100:101], v17 offset:49152
    ds_read_b64_tr_b16 v[102:103], v17 offset:49664
    v_mfma_f32_16x16x32_bf16 v[44:47], v[68:71], v[132:135], v[44:47]
    ds_read_b64_tr_b16 v[104:105], v18 offset:49152
    ds_read_b64_tr_b16 v[106:107], v18 offset:49664
    v_mfma_f32_16x16x32_bf16 v[48:51], v[72:75], v[128:131], v[48:51]
    ds_read_b64_tr_b16 v[108:109], v19 offset:49152
    ds_read_b64_tr_b16 v[110:111], v19 offset:49664
    v_mfma_f32_16x16x32_bf16 v[52:55], v[72:75], v[132:135], v[52:55]
    ds_read_b128 v[152:155], v25 offset:49152
    ds_read_b128 v[156:159], v27 offset:49152
    v_mfma_f32_16x16x32_bf16 v[56:59], v[76:79], v[128:131], v[56:59]
    ds_read_b64_tr_b16 v[112:113], v16 offset:53248
    ds_read_b64_tr_b16 v[114:115], v16 offset:53760
    v_mfma_f32_16x16x32_bf16 v[60:63], v[76:79], v[132:135], v[60:63]
    ds_read_b64_tr_b16 v[116:117], v17 offset:53248
    ds_read_b64_tr_b16 v[118:119], v17 offset:53760
    v_mfma_f32_16x16x32_bf16 v[32:35], v[80:83], v[136:139], v[32:35]
    ds_read_b64_tr_b16 v[120:121], v18 offset:53248
    ds_read_b64_tr_b16 v[122:123], v18 offset:53760
    v_mfma_f32_16x16x32_bf16 v[36:39], v[80:83], v[140:143], v[36:39]
    ds_read_b64_tr_b16 v[124:125], v19 offset:53248
    ds_read_b64_tr_b16 v[126:127], v19 offset:53760
    v_mfma_f32_16x16x32_bf16 v[40:43], v[84:87], v[136:139], v[40:43]
    v_mfma_f32_16x16x32_bf16 v[44:47], v[84:87], v[140:143], v[44:47]
    v_mfma_f32_16x16x32_bf16 v[48:51], v[88:91], v[136:139], v[48:51]
    v_mfma_f32_16x16x32_bf16 v[52:55], v[88:91], v[140:143], v[52:55]
    v_mfma_f32_16x16x32_bf16 v[56:59], v[92:95], v[136:139], v[56:59]
    v_mfma_f32_16x16x32_bf16 v[60:63], v[92:95], v[140:143], v[60:63]
    s_waitcnt lgkmcnt(0)
    s_barrier
    v_mfma_f32_16x16x32_bf16 v[32:35], v[96:99], v[144:147], v[32:35]
    ds_read_b128 v[128:131], v28 offset:0
    ds_read_b128 v[132:135], v30 offset:0
    v_mfma_f32_16x16x32_bf16 v[36:39], v[96:99], v[148:151], v[36:39]
    ds_read_b64_tr_b16 v[64:65], v20 offset:0
    ds_read_b64_tr_b16 v[66:67], v20 offset:512
    v_mfma_f32_16x16x32_bf16 v[40:43], v[100:103], v[144:147], v[40:43]
    ds_read_b64_tr_b16 v[68:69], v21 offset:0
    ds_read_b64_tr_b16 v[70:71], v21 offset:512
    v_mfma_f32_16x16x32_bf16 v[44:47], v[100:103], v[148:151], v[44:47]
    ds_read_b64_tr_b16 v[72:73], v22 offset:0
    ds_read_b64_tr_b16 v[74:75], v22 offset:512
    v_mfma_f32_16x16x32_bf16 v[48:51], v[104:107], v[144:147], v[48:51]
    ds_read_b64_tr_b16 v[76:77], v23 offset:0
    ds_read_b64_tr_b16 v[78:79], v23 offset:512
    v_mfma_f32_16x16x32_bf16 v[52:55], v[104:107], v[148:151], v[52:55]
    ds_read_b128 v[136:139], v29 offset:0
    ds_read_b128 v[140:143], v31 offset:0
    v_mfma_f32_16x16x32_bf16 v[56:59], v[108:111], v[144:147], v[56:59]
    ds_read_b64_tr_b16 v[80:81], v20 offset:4096
    ds_read_b64_tr_b16 v[82:83], v20 offset:4608
    v_mfma_f32_16x16x32_bf16 v[60:63], v[108:111], v[148:151], v[60:63]
    ds_read_b64_tr_b16 v[84:85], v21 offset:4096
    ds_read_b64_tr_b16 v[86:87], v21 offset:4608
    v_mfma_f32_16x16x32_bf16 v[32:35], v[112:115], v[152:155], v[32:35]
    ds_read_b64_tr_b16 v[88:89], v22 offset:4096
    ds_read_b64_tr_b16 v[90:91], v22 offset:4608
    v_mfma_f32_16x16x32_bf16 v[36:39], v[112:115], v[156:159], v[36:39]
    ds_read_b64_tr_b16 v[92:93], v23 offset:4096
    ds_read_b64_tr_b16 v[94:95], v23 offset:4608
    v_mfma_f32_16x16x32_bf16 v[40:43], v[116:119], v[152:155], v[40:43]
    v_mfma_f32_16x16x32_bf16 v[44:47], v[116:119], v[156:159], v[44:47]
    v_mfma_f32_16x16x32_bf16 v[48:51], v[120:123], v[152:155], v[48:51]
    v_mfma_f32_16x16x32_bf16 v[52:55], v[120:123], v[156:159], v[52:55]
    v_mfma_f32_16x16x32_bf16 v[56:59], v[124:127], v[152:155], v[56:59]
    v_mfma_f32_16x16x32_bf16 v[60:63], v[124:127], v[156:159], v[60:63]
    s_waitcnt lgkmcnt(0)
    s_barrier
    v_mfma_f32_16x16x32_bf16 v[32:35], v[64:67], v[128:131], v[32:35]
    ds_read_b128 v[144:147], v24 offset:0
    ds_read_b128 v[148:151], v26 offset:0
    v_mfma_f32_16x16x32_bf16 v[36:39], v[64:67], v[132:135], v[36:39]
    ds_read_b64_tr_b16 v[96:97], v16 offset:0
    ds_read_b64_tr_b16 v[98:99], v16 offset:512
    v_mfma_f32_16x16x32_bf16 v[40:43], v[68:71], v[128:131], v[40:43]
    ds_read_b64_tr_b16 v[100:101], v17 offset:0
    ds_read_b64_tr_b16 v[102:103], v17 offset:512
    v_mfma_f32_16x16x32_bf16 v[44:47], v[68:71], v[132:135], v[44:47]
    ds_read_b64_tr_b16 v[104:105], v18 offset:0
    ds_read_b64_tr_b16 v[106:107], v18 offset:512
    v_mfma_f32_16x16x32_bf16 v[48:51], v[72:75], v[128:131], v[48:51]
    ds_read_b64_tr_b16 v[108:109], v19 offset:0
    ds_read_b64_tr_b16 v[110:111], v19 offset:512
    v_mfma_f32_16x16x32_bf16 v[52:55], v[72:75], v[132:135], v[52:55]
    ds_read_b128 v[152:155], v25 offset:0
    ds_read_b128 v[156:159], v27 offset:0
    v_mfma_f32_16x16x32_bf16 v[56:59], v[76:79], v[128:131], v[56:59]
    ds_read_b64_tr_b16 v[112:113], v16 offset:4096
    ds_read_b64_tr_b16 v[114:115], v16 offset:4608
    v_mfma_f32_16x16x32_bf16 v[60:63], v[76:79], v[132:135], v[60:63]
    ds_read_b64_tr_b16 v[116:117], v17 offset:4096
    ds_read_b64_tr_b16 v[118:119], v17 offset:4608
    v_mfma_f32_16x16x32_bf16 v[32:35], v[80:83], v[136:139], v[32:35]
    ds_read_b64_tr_b16 v[120:121], v18 offset:4096
    ds_read_b64_tr_b16 v[122:123], v18 offset:4608
    v_mfma_f32_16x16x32_bf16 v[36:39], v[80:83], v[140:143], v[36:39]
    ds_read_b64_tr_b16 v[124:125], v19 offset:4096
    ds_read_b64_tr_b16 v[126:127], v19 offset:4608
    v_mfma_f32_16x16x32_bf16 v[40:43], v[84:87], v[136:139], v[40:43]
    v_mfma_f32_16x16x32_bf16 v[44:47], v[84:87], v[140:143], v[44:47]
    v_mfma_f32_16x16x32_bf16 v[48:51], v[88:91], v[136:139], v[48:51]
    v_mfma_f32_16x16x32_bf16 v[52:55], v[88:91], v[140:143], v[52:55]
    v_mfma_f32_16x16x32_bf16 v[56:59], v[92:95], v[136:139], v[56:59]
    v_mfma_f32_16x16x32_bf16 v[60:63], v[92:95], v[140:143], v[60:63]
    s_waitcnt lgkmcnt(0)
    s_barrier
    v_mfma_f32_16x16x32_bf16 v[32:35], v[96:99], v[144:147], v[32:35]
    ds_read_b128 v[128:131], v24 offset:16384
    ds_read_b128 v[132:135], v26 offset:16384
    v_mfma_f32_16x16x32_bf16 v[36:39], v[96:99], v[148:151], v[36:39]
    ds_read_b64_tr_b16 v[64:65], v16 offset:16384
    ds_read_b64_tr_b16 v[66:67], v16 offset:16896
    v_mfma_f32_16x16x32_bf16 v[40:43], v[100:103], v[144:147], v[40:43]
    ds_read_b64_tr_b16 v[68:69], v17 offset:16384
    ds_read_b64_tr_b16 v[70:71], v17 offset:16896
    v_mfma_f32_16x16x32_bf16 v[44:47], v[100:103], v[148:151], v[44:47]
    ds_read_b64_tr_b16 v[72:73], v18 offset:16384
    ds_read_b64_tr_b16 v[74:75], v18 offset:16896
    v_mfma_f32_16x16x32_bf16 v[48:51], v[104:107], v[144:147], v[48:51]
    ds_read_b64_tr_b16 v[76:77], v19 offset:16384
    ds_read_b64_tr_b16 v[78:79], v19 offset:16896
    v_mfma_f32_16x16x32_bf16 v[52:55], v[104:107], v[148:151], v[52:55]
    ds_read_b128 v[136:139], v25 offset:16384
    ds_read_b128 v[140:143], v27 offset:16384
    v_mfma_f32_16x16x32_bf16 v[56:59], v[108:111], v[144:147], v[56:59]
    ds_read_b64_tr_b16 v[80:81], v16 offset:20480
    ds_read_b64_tr_b16 v[82:83], v16 offset:20992
    v_mfma_f32_16x16x32_bf16 v[60:63], v[108:111], v[148:151], v[60:63]
    ds_read_b64_tr_b16 v[84:85], v17 offset:20480
    ds_read_b64_tr_b16 v[86:87], v17 offset:20992
    v_mfma_f32_16x16x32_bf16 v[32:35], v[112:115], v[152:155], v[32:35]
    ds_read_b64_tr_b16 v[88:89], v18 offset:20480
    ds_read_b64_tr_b16 v[90:91], v18 offset:20992
    v_mfma_f32_16x16x32_bf16 v[36:39], v[112:115], v[156:159], v[36:39]
    ds_read_b64_tr_b16 v[92:93], v19 offset:20480
    ds_read_b64_tr_b16 v[94:95], v19 offset:20992
    v_mfma_f32_16x16x32_bf16 v[40:43], v[116:119], v[152:155], v[40:43]
    v_mfma_f32_16x16x32_bf16 v[44:47], v[116:119], v[156:159], v[44:47]
    v_mfma_f32_16x16x32_bf16 v[48:51], v[120:123], v[152:155], v[48:51]
    v_mfma_f32_16x16x32_bf16 v[52:55], v[120:123], v[156:159], v[52:55]
    v_mfma_f32_16x16x32_bf16 v[56:59], v[124:127], v[152:155], v[56:59]
    v_mfma_f32_16x16x32_bf16 v[60:63], v[124:127], v[156:159], v[60:63]
    s_waitcnt lgkmcnt(0)
    v_mfma_f32_16x16x32_bf16 v[32:35], v[64:67], v[128:131], v[32:35]
    v_mfma_f32_16x16x32_bf16 v[36:39], v[64:67], v[132:135], v[36:39]
    v_mfma_f32_16x16x32_bf16 v[40:43], v[68:71], v[128:131], v[40:43]
    v_mfma_f32_16x16x32_bf16 v[44:47], v[68:71], v[132:135], v[44:47]
    v_mfma_f32_16x16x32_bf16 v[48:51], v[72:75], v[128:131], v[48:51]
    v_mfma_f32_16x16x32_bf16 v[52:55], v[72:75], v[132:135], v[52:55]
    v_mfma_f32_16x16x32_bf16 v[56:59], v[76:79], v[128:131], v[56:59]
    v_mfma_f32_16x16x32_bf16 v[60:63], v[76:79], v[132:135], v[60:63]
    v_mfma_f32_16x16x32_bf16 v[32:35], v[80:83], v[136:139], v[32:35]
    v_mfma_f32_16x16x32_bf16 v[36:39], v[80:83], v[140:143], v[36:39]
    v_mfma_f32_16x16x32_bf16 v[40:43], v[84:87], v[136:139], v[40:43]
    v_mfma_f32_16x16x32_bf16 v[44:47], v[84:87], v[140:143], v[44:47]
    v_mfma_f32_16x16x32_bf16 v[48:51], v[88:91], v[136:139], v[48:51]
    v_mfma_f32_16x16x32_bf16 v[52:55], v[88:91], v[140:143], v[52:55]
    v_mfma_f32_16x16x32_bf16 v[56:59], v[92:95], v[136:139], v[56:59]
    v_mfma_f32_16x16x32_bf16 v[60:63], v[92:95], v[140:143], v[60:63]
    v_and_b32 v8, 63, v0
    s_lshl_b32 s23, s20, 12
    s_add_u32 s23, s23, 32768
    v_lshl_add_u32 v9, v8, 4, s23
    v_xor_b32 v10, 4096, v9
    ds_write_b128 v9, v[36:39] offset:0
    ds_write_b128 v9, v[44:47] offset:1024
    ds_write_b128 v9, v[52:55] offset:2048
    ds_write_b128 v9, v[60:63] offset:3072
    v_and_b32 v11, 7, v2
    v_lshrrev_b32 v16, 1, v1
    v_xor_b32 v11, v11, v16
    v_and_b32 v16, 1, v1
    v_lshlrev_b32 v16, 3, v16
    v_lshl_add_u32 v16, v5, 7, v16
    v_add_u32 v16, 114688, v16
    v_xor_b32 v17, 0, v11
    v_lshl_add_u32 v12, v17, 4, v16
    v_xor_b32 v17, 2, v11
    v_lshl_add_u32 v13, v17, 4, v16
    v_xor_b32 v17, 4, v11
    v_lshl_add_u32 v14, v17, 4, v16
    v_xor_b32 v17, 6, v11
    v_lshl_add_u32 v15, v17, 4, v16
    v_lshrrev_b32 v22, 3, v8
    v_and_b32 v23, 7, v8
    v_xor_b32 v20, v22, v23
    v_lshlrev_b32 v20, 4, v20
    v_lshl_add_u32 v20, v22, 7, v20
    s_lshl_b32 s23, s20, 11
    s_add_u32 s23, s23, 114688
    v_add_u32 v20, s23, v20
    v_lshlrev_b32 v21, 10, v22
    v_lshl_add_u32 v21, v23, 4, v21
    s_lshl2_add_u32 s23, s21, s20
    s_lshl_b32 s23, s23, 14
    s_lshl_b32 s24, s22, 7
    s_add_u32 s23, s23, s24
    v_add_u32 v21, s23, v21
    s_waitcnt vmcnt(0) lgkmcnt(0)
    s_barrier
    ds_read_b128 v[64:67], v10 offset:0
    ds_read_b128 v[68:71], v10 offset:1024
    ds_read_b128 v[72:75], v10 offset:2048
    ds_read_b128 v[76:79], v10 offset:3072
    ds_read_b64 v[80:81], v12
    ds_read_b64 v[84:85], v13
    ds_read_b64 v[88:89], v14
    ds_read_b64 v[92:93], v15
    s_mov_b32 s23, 0xffff0000
    s_waitcnt lgkmcnt(7)
    v_pk_add_f32 v[32:33], v[32:33], v[64:65]
    v_pk_add_f32 v[34:35], v[34:35], v[66:67]
    s_waitcnt lgkmcnt(3)
    v_lshlrev_b32 v82, 16, v80
    v_and_b32 v83, s23, v80
    v_pk_fma_f32 v[64:65], v[32:33], v[160:161], v[82:83]
    v_cvt_pk_bf16_f32 v32, v64, v65
    v_lshlrev_b32 v82, 16, v81
    v_and_b32 v83, s23, v81
    v_pk_fma_f32 v[64:65], v[34:35], v[162:163], v[82:83]
    v_cvt_pk_bf16_f32 v33, v64, v65
    ds_write_b64 v12, v[32:33]
    s_waitcnt lgkmcnt(6)
    v_pk_add_f32 v[40:41], v[40:41], v[68:69]
    v_pk_add_f32 v[42:43], v[42:43], v[70:71]
    s_waitcnt lgkmcnt(2)
    v_lshlrev_b32 v86, 16, v84
    v_and_b32 v87, s23, v84
    v_pk_fma_f32 v[68:69], v[40:41], v[164:165], v[86:87]
    v_cvt_pk_bf16_f32 v40, v68, v69
    v_lshlrev_b32 v86, 16, v85
    v_and_b32 v87, s23, v85
    v_pk_fma_f32 v[68:69], v[42:43], v[166:167], v[86:87]
    v_cvt_pk_bf16_f32 v41, v68, v69
    ds_write_b64 v13, v[40:41]
    s_waitcnt lgkmcnt(5)
    v_pk_add_f32 v[48:49], v[48:49], v[72:73]
    v_pk_add_f32 v[50:51], v[50:51], v[74:75]
    s_waitcnt lgkmcnt(1)
    v_lshlrev_b32 v90, 16, v88
    v_and_b32 v91, s23, v88
    v_pk_fma_f32 v[72:73], v[48:49], v[168:169], v[90:91]
    v_cvt_pk_bf16_f32 v48, v72, v73
    v_lshlrev_b32 v90, 16, v89
    v_and_b32 v91, s23, v89
    v_pk_fma_f32 v[72:73], v[50:51], v[170:171], v[90:91]
    v_cvt_pk_bf16_f32 v49, v72, v73
    ds_write_b64 v14, v[48:49]
    s_waitcnt lgkmcnt(4)
    v_pk_add_f32 v[56:57], v[56:57], v[76:77]
    v_pk_add_f32 v[58:59], v[58:59], v[78:79]
    s_waitcnt lgkmcnt(0)
    v_lshlrev_b32 v94, 16, v92
    v_and_b32 v95, s23, v92
    v_pk_fma_f32 v[76:77], v[56:57], v[172:173], v[94:95]
    v_cvt_pk_bf16_f32 v56, v76, v77
    v_lshlrev_b32 v94, 16, v93
    v_and_b32 v95, s23, v93
    v_pk_fma_f32 v[76:77], v[58:59], v[174:175], v[94:95]
    v_cvt_pk_bf16_f32 v57, v76, v77
    ds_write_b64 v15, v[56:57]
    s_waitcnt lgkmcnt(0)
    ds_read_b128 v[128:131], v20 offset:0
    ds_read_b128 v[132:135], v20 offset:1024
    s_waitcnt lgkmcnt(1)
    global_store_dwordx4 v21, v[128:131], s[38:39]
    v_add_u32 v21, 8192, v21
    s_waitcnt lgkmcnt(0)
    global_store_dwordx4 v21, v[132:135], s[38:39]
    s_endpgm
adaLN_cond__spectral_fnet__mixer_gmlp__prompt_kernel_loader:
    s_mov_b32 s10, 1835008
    s_mov_b32 s11, 0x20000
    s_mov_b32 s6, 33554432
    s_mov_b32 s7, 0x20000
    s_sub_u32 s29, s20, 4
    v_and_b32 v11, 63, v0
    v_mul_u32_u24 v12, 4682, v11
    v_lshrrev_b32 v12, 16, v12
    v_mul_u32_u24 v14, 14, v12
    v_sub_u32 v13, v11, v14
    v_mul_u32_u24 v12, 3584, v12
    v_lshl_add_u32 v12, v13, 4, v12
    s_mul_i32 s23, s29, 57344
    v_add_u32 v5, s23, v12
    v_add_u32 v6, 13376, v5
    v_add_u32 v7, 26752, v5
    v_add_u32 v8, 40128, v5
    v_lshrrev_b32 v12, 3, v11
    v_and_b32 v13, 7, v11
    v_xor_b32 v13, v13, v12
    v_lshlrev_b32 v13, 4, v13
    v_lshl_add_u32 v12, v12, 10, v13
    s_lshl_b32 s23, s29, 14
    v_add_u32 v9, s23, v12
    v_add_u32 v10, 7168, v9
    s_mul_i32 s30, s22, 224
    s_lshl_b32 s31, s21, 16
    s_add_u32 s31, s31, 12582912
    s_mul_i32 s32, s29, 3840
    s_lshl_b32 s33, s29, 11
    s_waitcnt lgkmcnt(0)
    s_add_u32 m0, s32, 65536
    s_add_u32 s23, s30, 1792
    s_mov_b32 exec_hi, 0x00ffffff
    buffer_load_dwordx4 v5, s[8:11], s23 offen offset:0 lds
    buffer_load_dwordx4 v6, s[8:11], s23 offen offset:960 lds
    buffer_load_dwordx4 v7, s[8:11], s23 offen offset:1920 lds
    buffer_load_dwordx4 v8, s[8:11], s23 offen offset:2880 lds
    s_mov_b32 exec_hi, -1
    s_add_u32 m0, s32, 80896
    s_add_u32 s23, s30, 231168
    s_mov_b32 exec_hi, 0x00ffffff
    buffer_load_dwordx4 v5, s[8:11], s23 offen offset:0 lds
    buffer_load_dwordx4 v6, s[8:11], s23 offen offset:960 lds
    buffer_load_dwordx4 v7, s[8:11], s23 offen offset:1920 lds
    buffer_load_dwordx4 v8, s[8:11], s23 offen offset:2880 lds
    s_mov_b32 exec_hi, -1
    s_add_u32 m0, s32, 96256
    s_add_u32 s23, s30, 460544
    s_mov_b32 exec_hi, 0x00ffffff
    buffer_load_dwordx4 v5, s[8:11], s23 offen offset:0 lds
    buffer_load_dwordx4 v6, s[8:11], s23 offen offset:960 lds
    buffer_load_dwordx4 v7, s[8:11], s23 offen offset:1920 lds
    buffer_load_dwordx4 v8, s[8:11], s23 offen offset:2880 lds
    s_mov_b32 exec_hi, -1
    s_add_u32 m0, s32, 111616
    s_add_u32 s23, s30, 689920
    s_mov_b32 exec_hi, 0x00ffffff
    buffer_load_dwordx4 v5, s[8:11], s23 offen offset:0 lds
    buffer_load_dwordx4 v6, s[8:11], s23 offen offset:960 lds
    buffer_load_dwordx4 v7, s[8:11], s23 offen offset:1920 lds
    buffer_load_dwordx4 v8, s[8:11], s23 offen offset:2880 lds
    s_mov_b32 exec_hi, -1
    s_cmp_lg_u32 s20, 4
    s_cbranch_scc1 adaLN_cond__spectral_fnet__mixer_gmlp__prompt_kernel_db
    v_and_b32 v244, 63, v0
    s_lshr_b32 s24, s21, 3
    s_sub_u32 s25, 31, s21
    s_lshr_b32 s25, s25, 3
    v_cmp_lt_u32 vcc, 32, v244
    v_subrev_u32 v28, 32, v244
    s_nop 0
    v_cndmask_b32 v28, v244, v28, vcc
    v_mov_b32 v29, s24
    v_mov_b32 v30, s25
    v_cndmask_b32 v29, v29, v30, vcc
    v_and_b32 v30, 7, v28
    v_lshl_add_u32 v30, v29, 3, v30
    v_lshrrev_b32 v244, 3, v28
    v_lshl_add_u32 v30, v244, 5, v30
    v_add_u32 v29, 128, v29
    v_cmp_eq_u32 vcc, 32, v28
    s_nop 1
    v_cndmask_b32 v30, v30, v29, vcc
    s_mov_b32 s24, 360448
    v_lshl_add_u32 v244, v30, 7, s24
    s_mov_b32 s28, 0
adaLN_cond__spectral_fnet__mixer_gmlp__prompt_kernel_wb:
    global_load_dword v248, v244, s[4:5] sc1
    s_waitcnt vmcnt(0)
    v_xor_b32 v248, s64, v248
    v_cmp_ne_u32 vcc, 0, v248
    s_add_u32 s28, s28, 1
    s_cmp_eq_u64 vcc, 0
    s_cbranch_scc1 adaLN_cond__spectral_fnet__mixer_gmlp__prompt_kernel_db
    s_sleep 1
    s_cmp_lt_u32 s28, 262144
    s_cbranch_scc1 adaLN_cond__spectral_fnet__mixer_gmlp__prompt_kernel_wb
adaLN_cond__spectral_fnet__mixer_gmlp__prompt_kernel_db:
    s_barrier
    s_add_u32 m0, s33, 0
    s_add_u32 s23, s31, 0
    buffer_load_dwordx4 v9, s[4:7], s23 offen offset:0 sc1 lds
    buffer_load_dwordx4 v10, s[4:7], s23 offen offset:1024 sc1 lds
    s_add_u32 m0, s33, 8192
    s_add_u32 s23, s31, 128
    buffer_load_dwordx4 v9, s[4:7], s23 offen offset:0 sc1 lds
    buffer_load_dwordx4 v10, s[4:7], s23 offen offset:1024 sc1 lds
    s_add_u32 m0, s33, 16384
    s_add_u32 s23, s31, 256
    buffer_load_dwordx4 v9, s[4:7], s23 offen offset:0 sc1 lds
    buffer_load_dwordx4 v10, s[4:7], s23 offen offset:1024 sc1 lds
    s_add_u32 m0, s33, 24576
    s_add_u32 s23, s31, 384
    buffer_load_dwordx4 v9, s[4:7], s23 offen offset:0 sc1 lds
    buffer_load_dwordx4 v10, s[4:7], s23 offen offset:1024 sc1 lds
    s_add_u32 m0, s33, 32768
    s_add_u32 s23, s31, 512
    buffer_load_dwordx4 v9, s[4:7], s23 offen offset:0 sc1 lds
    buffer_load_dwordx4 v10, s[4:7], s23 offen offset:1024 sc1 lds
    s_add_u32 m0, s33, 40960
    s_add_u32 s23, s31, 640
    buffer_load_dwordx4 v9, s[4:7], s23 offen offset:0 sc1 lds
    buffer_load_dwordx4 v10, s[4:7], s23 offen offset:1024 sc1 lds
    s_add_u32 m0, s33, 49152
    s_add_u32 s23, s31, 768
    buffer_load_dwordx4 v9, s[4:7], s23 offen offset:0 sc1 lds
    buffer_load_dwordx4 v10, s[4:7], s23 offen offset:1024 sc1 lds
    s_add_u32 m0, s33, 57344
    s_add_u32 s23, s31, 896
    buffer_load_dwordx4 v9, s[4:7], s23 offen offset:0 sc1 lds
    buffer_load_dwordx4 v10, s[4:7], s23 offen offset:1024 sc1 lds
    s_or_b32 s23, s2, s29
    s_cbranch_scc1 adaLN_cond__spectral_fnet__mixer_gmlp__prompt_kernel_noep
    v_mov_b32 v244, 446464
    v_mov_b32 v245, s64
    s_mov_b64 exec, 1
    global_store_dword v244, v245, s[4:5] sc1
    s_mov_b64 exec, -1
adaLN_cond__spectral_fnet__mixer_gmlp__prompt_kernel_noep:
    v_lshrrev_b32 v12, 3, v11
    v_lshl_add_u32 v12, v12, 12, v13
    s_lshl_b32 s23, s29, 3
    s_mov_b32 s24, 0x060c0600
    s_lshr_b32 s24, s24, s23
    s_and_b32 s24, s24, 0xff
    s_mov_b32 s25, 0x03000903
    s_lshr_b32 s25, s25, s23
    s_and_b32 s25, s25, 0xff
    s_lshl_b32 s23, s24, 15
    v_add_u32 v16, s23, v12
    s_lshl_b32 s23, s25, 15
    v_add_u32 v19, s23, v12
    v_add_u32 v17, 31744, v16
    v_add_u32 v20, 31744, v19
    v_add_u32 v18, 63488, v16
    v_add_u32 v21, 63488, v19
    s_lshl_b32 s40, s24, 10
    s_lshl_b32 s41, s25, 10
    s_cmp_eq_u32 s29, 3
    s_cselect_b32 s23, 14336, 0
    s_add_u32 s40, s40, s23
    s_cmp_ge_u32 s29, 2
    s_cselect_b32 s23, 14336, 0
    s_add_u32 s41, s41, s23
    s_mul_i32 s23, s22, 458752
    s_add_u32 s23, s23, 20971520
    s_add_u32 s52, s4, s23
    s_addc_u32 s53, s5, 0
    s_lshl_b32 s23, s21, 18
    s_add_u32 s54, s12, s23
    s_addc_u32 s55, s13, 0
    s_cmp_eq_u32 s29, 3
    s_cselect_b32 s44, s54, s52
    s_cselect_b32 s45, s55, s53
    s_mov_b32 s46, 458752
    s_mov_b32 s47, 0x20000
    s_cmp_ge_u32 s29, 2
    s_cselect_b32 s48, s54, s52
    s_cselect_b32 s49, s55, s53
    s_mov_b32 s50, 458752
    s_mov_b32 s51, 0x20000
    s_waitcnt vmcnt(14)
    s_barrier
    s_waitcnt vmcnt(12)
    s_barrier
    s_add_u32 m0, s32, 65536
    s_add_u32 s23, s30, 919296
    s_mov_b32 exec_hi, 0x00ffffff
    buffer_load_dwordx4 v5, s[8:11], s23 offen offset:0 lds
    buffer_load_dwordx4 v6, s[8:11], s23 offen offset:960 lds
    buffer_load_dwordx4 v7, s[8:11], s23 offen offset:1920 lds
    buffer_load_dwordx4 v8, s[8:11], s23 offen offset:2880 lds
    s_mov_b32 exec_hi, -1
    s_waitcnt vmcnt(14)
    s_barrier
    s_add_u32 m0, s32, 80896
    s_add_u32 s23, s30, 1148672
    s_mov_b32 exec_hi, 0x00ffffff
    buffer_load_dwordx4 v5, s[8:11], s23 offen offset:0 lds
    buffer_load_dwordx4 v6, s[8:11], s23 offen offset:960 lds
    buffer_load_dwordx4 v7, s[8:11], s23 offen offset:1920 lds
    buffer_load_dwordx4 v8, s[8:11], s23 offen offset:2880 lds
    s_mov_b32 exec_hi, -1
    s_waitcnt vmcnt(16)
    s_barrier
    s_add_u32 m0, s32, 96256
    s_add_u32 s23, s30, 1378048
    s_mov_b32 exec_hi, 0x00ffffff
    buffer_load_dwordx4 v5, s[8:11], s23 offen offset:0 lds
    buffer_load_dwordx4 v6, s[8:11], s23 offen offset:960 lds
    buffer_load_dwordx4 v7, s[8:11], s23 offen offset:1920 lds
    buffer_load_dwordx4 v8, s[8:11], s23 offen offset:2880 lds
    s_mov_b32 exec_hi, -1
    s_waitcnt vmcnt(8)
    s_barrier
    s_add_u32 m0, s32, 111616
    s_add_u32 s23, s30, 1607424
    s_mov_b32 exec_hi, 0x00ffffff
    buffer_load_dwordx4 v5, s[8:11], s23 offen offset:0 lds
    buffer_load_dwordx4 v6, s[8:11], s23 offen offset:960 lds
    buffer_load_dwordx4 v7, s[8:11], s23 offen offset:1920 lds
    buffer_load_dwordx4 v8, s[8:11], s23 offen offset:2880 lds
    s_mov_b32 exec_hi, -1
    s_waitcnt vmcnt(8)
    s_barrier
    s_add_u32 m0, s32, 65536
    s_add_u32 s23, s30, 0
    s_mov_b32 exec_hi, 0x00ffffff
    buffer_load_dwordx4 v5, s[8:11], s23 offen offset:0 lds
    buffer_load_dwordx4 v6, s[8:11], s23 offen offset:960 lds
    buffer_load_dwordx4 v7, s[8:11], s23 offen offset:1920 lds
    buffer_load_dwordx4 v8, s[8:11], s23 offen offset:2880 lds
    s_mov_b32 exec_hi, -1
    s_waitcnt vmcnt(8)
    s_barrier
    s_add_u32 m0, s32, 80896
    s_add_u32 s23, s30, 229376
    s_mov_b32 exec_hi, 0x00ffffff
    buffer_load_dwordx4 v5, s[8:11], s23 offen offset:0 lds
    buffer_load_dwordx4 v6, s[8:11], s23 offen offset:960 lds
    buffer_load_dwordx4 v7, s[8:11], s23 offen offset:1920 lds
    buffer_load_dwordx4 v8, s[8:11], s23 offen offset:2880 lds
    s_mov_b32 exec_hi, -1
    s_waitcnt vmcnt(8)
    s_barrier
    s_add_u32 m0, s32, 96256
    s_add_u32 s23, s30, 458752
    s_mov_b32 exec_hi, 0x00ffffff
    buffer_load_dwordx4 v5, s[8:11], s23 offen offset:0 lds
    buffer_load_dwordx4 v6, s[8:11], s23 offen offset:960 lds
    buffer_load_dwordx4 v7, s[8:11], s23 offen offset:1920 lds
    buffer_load_dwordx4 v8, s[8:11], s23 offen offset:2880 lds
    s_mov_b32 exec_hi, -1
    s_waitcnt vmcnt(8)
    s_barrier
    s_add_u32 m0, s32, 111616
    s_add_u32 s23, s30, 688128
    s_mov_b32 exec_hi, 0x00ffffff
    buffer_load_dwordx4 v5, s[8:11], s23 offen offset:0 lds
    buffer_load_dwordx4 v6, s[8:11], s23 offen offset:960 lds
    buffer_load_dwordx4 v7, s[8:11], s23 offen offset:1920 lds
    buffer_load_dwordx4 v8, s[8:11], s23 offen offset:2880 lds
    s_mov_b32 exec_hi, -1
    s_waitcnt vmcnt(8)
    s_barrier
    s_add_u32 m0, s32, 65536
    s_add_u32 s23, s30, 917504
    s_mov_b32 exec_hi, 0x00ffffff
    buffer_load_dwordx4 v5, s[8:11], s23 offen offset:0 lds
    buffer_load_dwordx4 v6, s[8:11], s23 offen offset:960 lds
    buffer_load_dwordx4 v7, s[8:11], s23 offen offset:1920 lds
    buffer_load_dwordx4 v8, s[8:11], s23 offen offset:2880 lds
    s_mov_b32 exec_hi, -1
    s_waitcnt vmcnt(8)
    s_barrier
    s_add_u32 m0, s32, 80896
    s_add_u32 s23, s30, 1146880
    s_mov_b32 exec_hi, 0x00ffffff
    buffer_load_dwordx4 v5, s[8:11], s23 offen offset:0 lds
    buffer_load_dwordx4 v6, s[8:11], s23 offen offset:960 lds
    buffer_load_dwordx4 v7, s[8:11], s23 offen offset:1920 lds
    buffer_load_dwordx4 v8, s[8:11], s23 offen offset:2880 lds
    s_mov_b32 exec_hi, -1
    s_waitcnt vmcnt(8)
    s_barrier
    s_add_u32 m0, s32, 96256
    s_add_u32 s23, s30, 1376256
    s_mov_b32 exec_hi, 0x00ffffff
    buffer_load_dwordx4 v5, s[8:11], s23 offen offset:0 lds
    buffer_load_dwordx4 v6, s[8:11], s23 offen offset:960 lds
    buffer_load_dwordx4 v7, s[8:11], s23 offen offset:1920 lds
    buffer_load_dwordx4 v8, s[8:11], s23 offen offset:2880 lds
    s_mov_b32 exec_hi, -1
    s_waitcnt vmcnt(8)
    s_barrier
    s_add_u32 m0, s32, 111616
    s_add_u32 s23, s30, 1605632
    s_mov_b32 exec_hi, 0x00ffffff
    buffer_load_dwordx4 v5, s[8:11], s23 offen offset:0 lds
    buffer_load_dwordx4 v6, s[8:11], s23 offen offset:960 lds
    buffer_load_dwordx4 v7, s[8:11], s23 offen offset:1920 lds
    buffer_load_dwordx4 v8, s[8:11], s23 offen offset:2880 lds
    s_mov_b32 exec_hi, -1
    s_waitcnt vmcnt(8)
    s_barrier
    s_waitcnt vmcnt(4)
    s_barrier
    s_waitcnt vmcnt(0)
    s_barrier
    s_lshl1_add_u32 s24, s21, s26
    s_lshl_b32 s24, s24, 12
    s_add_u32 s24, s24, 65536
    v_and_b32 v88, 31, v3
    v_lshl_add_u32 v88, v88, 3, s24
    v_lshl_add_u32 v88, v1, 10, v88
    v_and_b32 v89, 31, v4
    v_lshl_add_u32 v89, v89, 3, s24
    v_lshl_add_u32 v89, v1, 10, v89
    s_mul_i32 s23, s29, 4608
    s_add_u32 s23, s23, 126976
    v_and_b32 v90, 31, v3
    v_mul_u32_u24 v90, 144, v90
    v_lshl_add_u32 v90, v1, 3, v90
    v_add_u32 v90, s23, v90
    v_and_b32 v91, 31, v4
    v_mul_u32_u24 v91, 144, v91
    v_lshl_add_u32 v91, v1, 3, v91
    v_add_u32 v91, s23, v91
    v_lshrrev_b32 v12, 2, v2
    v_lshl_add_u32 v12, v1, 3, v12
    v_mul_u32_u24 v9, 144, v12
    v_and_b32 v13, 3, v2
    v_lshl_add_u32 v9, v13, 3, v9
    v_add_u32 v9, s23, v9
    s_mul_i32 s24, s27, 2304
    s_add_u32 s24, s24, 96
    v_add_u32 v5, s24, v9
    v_lshlrev_b32 v10, 12, v2
    v_lshl_add_u32 v10, v1, 4, v10
    s_mul_i32 s24, s22, 458752
    s_lshl_b32 s25, s21, 7
    s_add_u32 s24, s24, s25
    s_lshl_b32 s25, s26, 6
    s_add_u32 s24, s24, s25
    s_add_u32 s24, s24, 20971520
    s_lshl_b32 s25, s27, 5
    s_add_u32 s25, s25, 196608
    s_add_u32 s25, s25, s24
    v_add_u32 v6, s25, v10
    s_lshl_b32 s25, s27, 18
    s_add_u32 s24, s24, s25
    v_add_u32 v10, s24, v10
    ds_read_b64 v[52:53], v90 offset:0
    ds_read_b64 v[54:55], v91 offset:0
    ds_read_b64 v[56:57], v90 offset:32
    ds_read_b64 v[58:59], v91 offset:32
    ds_read_b64 v[60:61], v90 offset:64
    ds_read_b64 v[62:63], v91 offset:64
    ds_read_b64 v[64:65], v90 offset:96
    s_barrier
    s_cmp_lt_u32 s29, 2
    s_cbranch_scc1 adaLN_cond__spectral_fnet__mixer_gmlp__prompt_kernel_nob
    s_mov_b32 s42, 0
    s_add_u32 m0, s41, 0
    s_nop 0
    buffer_load_dwordx4 v19, s[48:51], s42 offen offset:0 sc1 lds
    buffer_load_dwordx4 v20, s[48:51], s42 offen offset:1024 sc1 lds
    buffer_load_dwordx4 v21, s[48:51], s42 offen offset:2048 sc1 lds
    s_add_u32 m0, s41, 22528
    s_add_u32 s42, s42, 128
    buffer_load_dwordx4 v19, s[48:51], s42 offen offset:0 sc1 lds
    buffer_load_dwordx4 v20, s[48:51], s42 offen offset:1024 sc1 lds
    buffer_load_dwordx4 v21, s[48:51], s42 offen offset:2048 sc1 lds
    s_add_u32 m0, s41, 45056
    s_add_u32 s42, s42, 128
    buffer_load_dwordx4 v19, s[48:51], s42 offen offset:0 sc1 lds
    buffer_load_dwordx4 v20, s[48:51], s42 offen offset:1024 sc1 lds
    buffer_load_dwordx4 v21, s[48:51], s42 offen offset:2048 sc1 lds
    s_add_u32 m0, s41, 67584
    s_add_u32 s42, s42, 128
    buffer_load_dwordx4 v19, s[48:51], s42 offen offset:0 sc1 lds
    buffer_load_dwordx4 v20, s[48:51], s42 offen offset:1024 sc1 lds
    buffer_load_dwordx4 v21, s[48:51], s42 offen offset:2048 sc1 lds
    s_add_u32 m0, s41, 90112
    s_add_u32 s42, s42, 128
    buffer_load_dwordx4 v19, s[48:51], s42 offen offset:0 sc1 lds
    buffer_load_dwordx4 v20, s[48:51], s42 offen offset:1024 sc1 lds
    buffer_load_dwordx4 v21, s[48:51], s42 offen offset:2048 sc1 lds
adaLN_cond__spectral_fnet__mixer_gmlp__prompt_kernel_nob:
    s_mov_b32 s28, 0
adaLN_cond__spectral_fnet__mixer_gmlp__prompt_kernel_poll:
    global_load_dwordx2 v[72:73], v88, s[4:5] offset:0 sc1
    global_load_dwordx2 v[74:75], v88, s[4:5] offset:256 sc1
    global_load_dwordx2 v[76:77], v88, s[4:5] offset:512 sc1
    global_load_dwordx2 v[78:79], v88, s[4:5] offset:768 sc1
    global_load_dwordx2 v[80:81], v89, s[4:5] offset:0 sc1
    global_load_dwordx2 v[82:83], v89, s[4:5] offset:256 sc1
    global_load_dwordx2 v[84:85], v89, s[4:5] offset:512 sc1
    global_load_dwordx2 v[86:87], v89, s[4:5] offset:768 sc1
    s_waitcnt vmcnt(0)
    v_max3_u32 v28, v72, v73, v74
    v_max3_u32 v28, v28, v75, v76
    v_max3_u32 v28, v28, v77, v78
    v_max3_u32 v28, v28, v79, v80
    v_max3_u32 v28, v28, v81, v82
    v_max3_u32 v28, v28, v83, v84
    v_max3_u32 v28, v28, v85, v86
    v_max_u32 v28, v28, v87
    v_cmp_eq_u32 vcc, -1, v28
    s_add_u32 s28, s28, 1
    s_cmp_eq_u64 vcc, 0
    s_cbranch_scc1 adaLN_cond__spectral_fnet__mixer_gmlp__prompt_kernel_polled
    s_sleep 2
    s_cmp_lt_u32 s28, 262144
    s_cbranch_scc1 adaLN_cond__spectral_fnet__mixer_gmlp__prompt_kernel_poll
adaLN_cond__spectral_fnet__mixer_gmlp__prompt_kernel_polled:
    v_pk_add_f32 v[72:73], v[72:73], v[74:75]
    v_pk_add_f32 v[76:77], v[76:77], v[78:79]
    v_pk_add_f32 v[72:73], v[72:73], v[76:77]
    v_mov_b32 v28, v72
    v_mov_b32 v30, v73
    v_pk_add_f32 v[80:81], v[80:81], v[82:83]
    v_pk_add_f32 v[84:85], v[84:85], v[86:87]
    v_pk_add_f32 v[80:81], v[80:81], v[84:85]
    v_mov_b32 v29, v80
    v_mov_b32 v31, v81
    v_mov_b32 v34, v28
    s_nop 1
    v_permlane16_swap_b32 v28, v34
    v_add_f32 v28, v28, v34
    v_mov_b32 v34, v28
    s_nop 1
    v_permlane32_swap_b32 v28, v34
    v_add_f32 v28, v28, v34
    v_mov_b32 v34, v29
    s_nop 1
    v_permlane16_swap_b32 v29, v34
    v_add_f32 v29, v29, v34
    v_mov_b32 v34, v29
    s_nop 1
    v_permlane32_swap_b32 v29, v34
    v_add_f32 v29, v29, v34
    v_mov_b32 v34, v30
    s_nop 1
    v_permlane16_swap_b32 v30, v34
    v_add_f32 v30, v30, v34
    v_mov_b32 v34, v30
    s_nop 1
    v_permlane32_swap_b32 v30, v34
    v_add_f32 v30, v30, v34
    v_mov_b32 v34, v31
    s_nop 1
    v_permlane16_swap_b32 v31, v34
    v_add_f32 v31, v31, v34
    v_mov_b32 v34, v31
    s_nop 1
    v_permlane32_swap_b32 v31, v34
    v_add_f32 v31, v31, v34
    v_mul_f32 v28, 0x3a924925, v28
    v_mul_f32 v30, 0x3a924925, v30
    v_fma_f32 v30, -v28, v28, v30
    v_max_f32 v30, 0, v30
    v_add_f32 v30, 0x3727c5ac, v30
    v_rsq_f32 v30, v30
    s_nop 0
    v_mul_f32 v28, v28, v30
    v_mul_f32 v29, 0x3a924925, v29
    v_mul_f32 v31, 0x3a924925, v31
    v_fma_f32 v31, -v29, v29, v31
    v_max_f32 v31, 0, v31
    v_add_f32 v31, 0x3727c5ac, v31
    v_rsq_f32 v31, v31
    s_nop 0
    v_mul_f32 v29, v29, v31
    v_mov_b32 v66, v30
    v_sub_f32 v67, 0, v28
    v_mov_b32 v68, v31
    v_sub_f32 v69, 0, v29
    s_mov_b32 s23, 0xffff0000
    s_waitcnt lgkmcnt(0)
    v_lshlrev_b32 v32, 16, v52
    v_and_b32 v33, s23, v52
    v_pk_fma_f32 v[32:33], v[32:33], v[66:67], v[66:67] op_sel:[0,0,1] op_sel_hi:[1,0,1]
    v_cvt_pk_bf16_f32 v52, v32, v33
    v_lshlrev_b32 v32, 16, v53
    v_and_b32 v33, s23, v53
    v_pk_fma_f32 v[32:33], v[32:33], v[66:67], v[66:67] op_sel:[0,0,1] op_sel_hi:[1,0,1]
    v_cvt_pk_bf16_f32 v53, v32, v33
    ds_write_b64 v90, v[52:53] offset:0
    v_lshlrev_b32 v32, 16, v54
    v_and_b32 v33, s23, v54
    v_pk_fma_f32 v[32:33], v[32:33], v[68:69], v[68:69] op_sel:[0,0,1] op_sel_hi:[1,0,1]
    v_cvt_pk_bf16_f32 v54, v32, v33
    v_lshlrev_b32 v32, 16, v55
    v_and_b32 v33, s23, v55
    v_pk_fma_f32 v[32:33], v[32:33], v[68:69], v[68:69] op_sel:[0,0,1] op_sel_hi:[1,0,1]
    v_cvt_pk_bf16_f32 v55, v32, v33
    ds_write_b64 v91, v[54:55] offset:0
    v_lshlrev_b32 v32, 16, v56
    v_and_b32 v33, s23, v56
    v_pk_fma_f32 v[32:33], v[32:33], v[66:67], v[66:67] op_sel:[0,0,1] op_sel_hi:[1,0,1]
    v_cvt_pk_bf16_f32 v56, v32, v33
    v_lshlrev_b32 v32, 16, v57
    v_and_b32 v33, s23, v57
    v_pk_fma_f32 v[32:33], v[32:33], v[66:67], v[66:67] op_sel:[0,0,1] op_sel_hi:[1,0,1]
    v_cvt_pk_bf16_f32 v57, v32, v33
    ds_write_b64 v90, v[56:57] offset:32
    v_lshlrev_b32 v32, 16, v58
    v_and_b32 v33, s23, v58
    v_pk_fma_f32 v[32:33], v[32:33], v[68:69], v[68:69] op_sel:[0,0,1] op_sel_hi:[1,0,1]
    v_cvt_pk_bf16_f32 v58, v32, v33
    v_lshlrev_b32 v32, 16, v59
    v_and_b32 v33, s23, v59
    v_pk_fma_f32 v[32:33], v[32:33], v[68:69], v[68:69] op_sel:[0,0,1] op_sel_hi:[1,0,1]
    v_cvt_pk_bf16_f32 v59, v32, v33
    ds_write_b64 v91, v[58:59] offset:32
    v_lshlrev_b32 v32, 16, v60
    v_and_b32 v33, s23, v60
    v_pk_fma_f32 v[32:33], v[32:33], v[66:67], v[66:67] op_sel:[0,0,1] op_sel_hi:[1,0,1]
    v_cvt_pk_bf16_f32 v60, v32, v33
    v_lshlrev_b32 v32, 16, v61
    v_and_b32 v33, s23, v61
    v_pk_fma_f32 v[32:33], v[32:33], v[66:67], v[66:67] op_sel:[0,0,1] op_sel_hi:[1,0,1]
    v_cvt_pk_bf16_f32 v61, v32, v33
    ds_write_b64 v90, v[60:61] offset:64
    v_lshlrev_b32 v32, 16, v62
    v_and_b32 v33, s23, v62
    v_pk_fma_f32 v[32:33], v[32:33], v[68:69], v[68:69] op_sel:[0,0,1] op_sel_hi:[1,0,1]
    v_cvt_pk_bf16_f32 v62, v32, v33
    v_lshlrev_b32 v32, 16, v63
    v_and_b32 v33, s23, v63
    v_pk_fma_f32 v[32:33], v[32:33], v[68:69], v[68:69] op_sel:[0,0,1] op_sel_hi:[1,0,1]
    v_cvt_pk_bf16_f32 v63, v32, v33
    ds_write_b64 v91, v[62:63] offset:64
    v_lshlrev_b32 v32, 16, v64
    v_and_b32 v33, s23, v64
    v_pk_fma_f32 v[32:33], v[32:33], v[66:67], v[66:67] op_sel:[0,0,1] op_sel_hi:[1,0,1]
    v_cvt_pk_bf16_f32 v64, v32, v33
    v_lshlrev_b32 v32, 16, v65
    v_and_b32 v33, s23, v65
    v_pk_fma_f32 v[32:33], v[32:33], v[66:67], v[66:67] op_sel:[0,0,1] op_sel_hi:[1,0,1]
    v_cvt_pk_bf16_f32 v65, v32, v33
    ds_write_b64 v90, v[64:65] offset:96
    s_waitcnt lgkmcnt(0)
    ds_read_b64_tr_b16 v[36:37], v9 offset:0
    ds_read_b64_tr_b16 v[38:39], v9 offset:576
    ds_read_b64_tr_b16 v[40:41], v9 offset:32
    ds_read_b64_tr_b16 v[42:43], v9 offset:608
    ds_read_b64_tr_b16 v[44:45], v9 offset:64
    ds_read_b64_tr_b16 v[46:47], v9 offset:640
    ds_read_b64_tr_b16 v[48:49], v5 offset:0
    ds_read_b64_tr_b16 v[50:51], v5 offset:576
    s_waitcnt lgkmcnt(6)
    global_store_dwordx4 v10, v[36:39], s[4:5] sc1
    v_add_u32 v10, 65536, v10
    s_waitcnt lgkmcnt(4)
    global_store_dwordx4 v10, v[40:43], s[4:5] sc1
    v_add_u32 v10, 65536, v10
    s_waitcnt lgkmcnt(2)
    global_store_dwordx4 v10, v[44:47], s[4:5] sc1
    s_waitcnt lgkmcnt(0)
    s_mov_b32 exec_hi, 0
    global_store_dwordx4 v6, v[48:51], s[4:5] sc1
    s_mov_b32 exec_hi, -1
    s_lshl_b32 s23, s22, 5
    s_add_u32 s23, s23, s21
    s_lshl_b32 s23, s23, 7
    s_add_u32 s23, s23, 380928
    v_mov_b32 v250, 159744
    v_mov_b32 v251, 1
    s_waitcnt vmcnt(0)
    s_mov_b64 exec, 1
    ds_add_rtn_u32 v250, v250, v251
    s_waitcnt lgkmcnt(0)
    v_readfirstlane_b32 s24, v250
    v_mov_b32 v250, s23
    v_mov_b32 v251, s64
    s_cmp_lg_u32 s24, 3
    s_cbranch_scc1 adaLN_cond__spectral_fnet__mixer_gmlp__prompt_kernel_noflz
    global_store_dword v250, v251, s[4:5] sc1
adaLN_cond__spectral_fnet__mixer_gmlp__prompt_kernel_noflz:
    s_mov_b64 exec, -1
    s_lshl_b32 s25, s22, 12
    s_add_u32 s25, s25, 380928
    s_cmp_lg_u32 s20, 4
    s_cbranch_scc1 adaLN_cond__spectral_fnet__mixer_gmlp__prompt_kernel_dc
    v_and_b32 v244, 63, v0
    v_and_b32 v244, 31, v244
    v_lshl_add_u32 v244, v244, 7, s25
    s_mov_b32 s28, 0
adaLN_cond__spectral_fnet__mixer_gmlp__prompt_kernel_wc:
    global_load_dword v248, v244, s[4:5] sc1
    s_waitcnt vmcnt(0)
    v_xor_b32 v248, s64, v248
    v_cmp_ne_u32 vcc, 0, v248
    s_add_u32 s28, s28, 1
    s_cmp_eq_u64 vcc, 0
    s_cbranch_scc1 adaLN_cond__spectral_fnet__mixer_gmlp__prompt_kernel_dc
    s_sleep 1
    s_cmp_lt_u32 s28, 262144
    s_cbranch_scc1 adaLN_cond__spectral_fnet__mixer_gmlp__prompt_kernel_wc
adaLN_cond__spectral_fnet__mixer_gmlp__prompt_kernel_dc:
    s_barrier
    s_cmp_ge_u32 s29, 2
    s_cbranch_scc1 adaLN_cond__spectral_fnet__mixer_gmlp__prompt_kernel_ldY
    s_mov_b32 s42, 0
    s_add_u32 m0, s40, 0
    s_nop 0
    buffer_load_dwordx4 v16, s[44:47], s42 offen offset:0 sc1 lds
    buffer_load_dwordx4 v17, s[44:47], s42 offen offset:1024 sc1 lds
    buffer_load_dwordx4 v18, s[44:47], s42 offen offset:2048 sc1 lds
    s_add_u32 m0, s41, 0
    s_nop 0
    buffer_load_dwordx4 v19, s[48:51], s42 offen offset:0 sc1 lds
    buffer_load_dwordx4 v20, s[48:51], s42 offen offset:1024 sc1 lds
    buffer_load_dwordx4 v21, s[48:51], s42 offen offset:2048 sc1 lds
    s_add_u32 m0, s40, 22528
    s_add_u32 s42, s42, 128
    buffer_load_dwordx4 v16, s[44:47], s42 offen offset:0 sc1 lds
    buffer_load_dwordx4 v17, s[44:47], s42 offen offset:1024 sc1 lds
    buffer_load_dwordx4 v18, s[44:47], s42 offen offset:2048 sc1 lds
    s_add_u32 m0, s41, 22528
    s_nop 0
    buffer_load_dwordx4 v19, s[48:51], s42 offen offset:0 sc1 lds
    buffer_load_dwordx4 v20, s[48:51], s42 offen offset:1024 sc1 lds
    buffer_load_dwordx4 v21, s[48:51], s42 offen offset:2048 sc1 lds
    s_add_u32 m0, s40, 45056
    s_add_u32 s42, s42, 128
    buffer_load_dwordx4 v16, s[44:47], s42 offen offset:0 sc1 lds
    buffer_load_dwordx4 v17, s[44:47], s42 offen offset:1024 sc1 lds
    buffer_load_dwordx4 v18, s[44:47], s42 offen offset:2048 sc1 lds
    s_add_u32 m0, s41, 45056
    s_nop 0
    buffer_load_dwordx4 v19, s[48:51], s42 offen offset:0 sc1 lds
    buffer_load_dwordx4 v20, s[48:51], s42 offen offset:1024 sc1 lds
    buffer_load_dwordx4 v21, s[48:51], s42 offen offset:2048 sc1 lds
    s_add_u32 m0, s40, 67584
    s_add_u32 s42, s42, 128
    buffer_load_dwordx4 v16, s[44:47], s42 offen offset:0 sc1 lds
    buffer_load_dwordx4 v17, s[44:47], s42 offen offset:1024 sc1 lds
    buffer_load_dwordx4 v18, s[44:47], s42 offen offset:2048 sc1 lds
    s_add_u32 m0, s41, 67584
    s_nop 0
    buffer_load_dwordx4 v19, s[48:51], s42 offen offset:0 sc1 lds
    buffer_load_dwordx4 v20, s[48:51], s42 offen offset:1024 sc1 lds
    buffer_load_dwordx4 v21, s[48:51], s42 offen offset:2048 sc1 lds
    s_add_u32 m0, s40, 90112
    s_add_u32 s42, s42, 128
    buffer_load_dwordx4 v16, s[44:47], s42 offen offset:0 sc1 lds
    buffer_load_dwordx4 v17, s[44:47], s42 offen offset:1024 sc1 lds
    buffer_load_dwordx4 v18, s[44:47], s42 offen offset:2048 sc1 lds
    s_add_u32 m0, s41, 90112
    s_nop 0
    buffer_load_dwordx4 v19, s[48:51], s42 offen offset:0 sc1 lds
    buffer_load_dwordx4 v20, s[48:51], s42 offen offset:1024 sc1 lds
    buffer_load_dwordx4 v21, s[48:51], s42 offen offset:2048 sc1 lds
    s_add_u32 s42, s42, 128
    s_mov_b32 s34, 0
    s_waitcnt vmcnt(24)
    s_barrier
    s_waitcnt vmcnt(18)
    s_barrier
    s_add_u32 m0, s34, s40
    s_add_u32 s23, s34, s41
    buffer_load_dwordx4 v16, s[44:47], s42 offen offset:0 sc1 lds
    buffer_load_dwordx4 v17, s[44:47], s42 offen offset:1024 sc1 lds
    buffer_load_dwordx4 v18, s[44:47], s42 offen offset:2048 sc1 lds
    s_mov_b32 m0, s23
    s_add_u32 s34, s34, 22528
    buffer_load_dwordx4 v19, s[48:51], s42 offen offset:0 sc1 lds
    buffer_load_dwordx4 v20, s[48:51], s42 offen offset:1024 sc1 lds
    buffer_load_dwordx4 v21, s[48:51], s42 offen offset:2048 sc1 lds
    s_add_u32 s42, s42, 128
    s_cmp_ge_u32 s34, 112640
    s_cselect_b32 s34, 0, s34
    s_waitcnt vmcnt(18)
    s_barrier
    s_add_u32 m0, s34, s40
    s_add_u32 s23, s34, s41
    buffer_load_dwordx4 v16, s[44:47], s42 offen offset:0 sc1 lds
    buffer_load_dwordx4 v17, s[44:47], s42 offen offset:1024 sc1 lds
    buffer_load_dwordx4 v18, s[44:47], s42 offen offset:2048 sc1 lds
    s_mov_b32 m0, s23
    s_add_u32 s34, s34, 22528
    buffer_load_dwordx4 v19, s[48:51], s42 offen offset:0 sc1 lds
    buffer_load_dwordx4 v20, s[48:51], s42 offen offset:1024 sc1 lds
    buffer_load_dwordx4 v21, s[48:51], s42 offen offset:2048 sc1 lds
    s_add_u32 s42, s42, 128
    s_cmp_ge_u32 s34, 112640
    s_cselect_b32 s34, 0, s34
    s_waitcnt vmcnt(18)
    s_barrier
    s_add_u32 m0, s34, s40
    s_add_u32 s23, s34, s41
    buffer_load_dwordx4 v16, s[44:47], s42 offen offset:0 sc1 lds
    buffer_load_dwordx4 v17, s[44:47], s42 offen offset:1024 sc1 lds
    buffer_load_dwordx4 v18, s[44:47], s42 offen offset:2048 sc1 lds
    s_mov_b32 m0, s23
    s_add_u32 s34, s34, 22528
    buffer_load_dwordx4 v19, s[48:51], s42 offen offset:0 sc1 lds
    buffer_load_dwordx4 v20, s[48:51], s42 offen offset:1024 sc1 lds
    buffer_load_dwordx4 v21, s[48:51], s42 offen offset:2048 sc1 lds
    s_add_u32 s42, s42, 128
    s_cmp_ge_u32 s34, 112640
    s_cselect_b32 s34, 0, s34
    s_waitcnt vmcnt(18)
    s_barrier
    s_add_u32 m0, s34, s40
    s_add_u32 s23, s34, s41
    buffer_load_dwordx4 v16, s[44:47], s42 offen offset:0 sc1 lds
    buffer_load_dwordx4 v17, s[44:47], s42 offen offset:1024 sc1 lds
    buffer_load_dwordx4 v18, s[44:47], s42 offen offset:2048 sc1 lds
    s_mov_b32 m0, s23
    s_add_u32 s34, s34, 22528
    buffer_load_dwordx4 v19, s[48:51], s42 offen offset:0 sc1 lds
    buffer_load_dwordx4 v20, s[48:51], s42 offen offset:1024 sc1 lds
    buffer_load_dwordx4 v21, s[48:51], s42 offen offset:2048 sc1 lds
    s_add_u32 s42, s42, 128
    s_cmp_ge_u32 s34, 112640
    s_cselect_b32 s34, 0, s34
    s_waitcnt vmcnt(18)
    s_barrier
    s_add_u32 m0, s34, s40
    s_add_u32 s23, s34, s41
    buffer_load_dwordx4 v16, s[44:47], s42 offen offset:0 sc1 lds
    buffer_load_dwordx4 v17, s[44:47], s42 offen offset:1024 sc1 lds
    buffer_load_dwordx4 v18, s[44:47], s42 offen offset:2048 sc1 lds
    s_mov_b32 m0, s23
    s_add_u32 s34, s34, 22528
    buffer_load_dwordx4 v19, s[48:51], s42 offen offset:0 sc1 lds
    buffer_load_dwordx4 v20, s[48:51], s42 offen offset:1024 sc1 lds
    buffer_load_dwordx4 v21, s[48:51], s42 offen offset:2048 sc1 lds
    s_add_u32 s42, s42, 128
    s_cmp_ge_u32 s34, 112640
    s_cselect_b32 s34, 0, s34
    s_mov_b32 s35, 6
adaLN_cond__spectral_fnet__mixer_gmlp__prompt_kernel_glX:
    s_waitcnt vmcnt(18)
    s_barrier
    s_add_u32 m0, s34, s40
    s_add_u32 s23, s34, s41
    buffer_load_dwordx4 v16, s[44:47], s42 offen offset:0 sc1 lds
    buffer_load_dwordx4 v17, s[44:47], s42 offen offset:1024 sc1 lds
    buffer_load_dwordx4 v18, s[44:47], s42 offen offset:2048 sc1 lds
    s_mov_b32 m0, s23
    s_add_u32 s34, s34, 22528
    buffer_load_dwordx4 v19, s[48:51], s42 offen offset:0 sc1 lds
    buffer_load_dwordx4 v20, s[48:51], s42 offen offset:1024 sc1 lds
    buffer_load_dwordx4 v21, s[48:51], s42 offen offset:2048 sc1 lds
    s_add_u32 s42, s42, 128
    s_cmp_ge_u32 s34, 112640
    s_cselect_b32 s34, 0, s34
    s_add_u32 s35, s35, 1
    s_cmp_le_u32 s35, 27
    s_cbranch_scc1 adaLN_cond__spectral_fnet__mixer_gmlp__prompt_kernel_glX
    s_waitcnt vmcnt(18)
    s_barrier
    s_waitcnt vmcnt(12)
    s_barrier
    s_waitcnt vmcnt(6)
    s_barrier
    s_waitcnt vmcnt(0)
    s_barrier
    s_branch adaLN_cond__spectral_fnet__mixer_gmlp__prompt_kernel_gdone
adaLN_cond__spectral_fnet__mixer_gmlp__prompt_kernel_ldY:
    s_mov_b32 s42, 0
    s_add_u32 m0, s40, 0
    s_nop 0
    buffer_load_dwordx4 v16, s[44:47], s42 offen offset:0 sc1 lds
    buffer_load_dwordx4 v17, s[44:47], s42 offen offset:1024 sc1 lds
    s_add_u32 m0, s40, 22528
    s_add_u32 s42, s42, 128
    buffer_load_dwordx4 v16, s[44:47], s42 offen offset:0 sc1 lds
    buffer_load_dwordx4 v17, s[44:47], s42 offen offset:1024 sc1 lds
    s_add_u32 m0, s40, 45056
    s_add_u32 s42, s42, 128
    buffer_load_dwordx4 v16, s[44:47], s42 offen offset:0 sc1 lds
    buffer_load_dwordx4 v17, s[44:47], s42 offen offset:1024 sc1 lds
    s_add_u32 m0, s40, 67584
    s_add_u32 s42, s42, 128
    buffer_load_dwordx4 v16, s[44:47], s42 offen offset:0 sc1 lds
    buffer_load_dwordx4 v17, s[44:47], s42 offen offset:1024 sc1 lds
    s_add_u32 m0, s40, 90112
    s_add_u32 s42, s42, 128
    buffer_load_dwordx4 v16, s[44:47], s42 offen offset:0 sc1 lds
    buffer_load_dwordx4 v17, s[44:47], s42 offen offset:1024 sc1 lds
    s_add_u32 s42, s42, 128
    s_mov_b32 s34, 0
    s_waitcnt vmcnt(8)
    s_barrier
    s_waitcnt vmcnt(6)
    s_barrier
    s_add_u32 m0, s34, s40
    s_add_u32 s23, s34, s41
    buffer_load_dwordx4 v16, s[44:47], s42 offen offset:0 sc1 lds
    buffer_load_dwordx4 v17, s[44:47], s42 offen offset:1024 sc1 lds
    s_mov_b32 m0, s23
    s_add_u32 s34, s34, 22528
    buffer_load_dwordx4 v19, s[48:51], s42 offen offset:0 sc1 lds
    buffer_load_dwordx4 v20, s[48:51], s42 offen offset:1024 sc1 lds
    buffer_load_dwordx4 v21, s[48:51], s42 offen offset:2048 sc1 lds
    s_add_u32 s42, s42, 128
    s_cmp_ge_u32 s34, 112640
    s_cselect_b32 s34, 0, s34
    s_waitcnt vmcnt(9)
    s_barrier
    s_add_u32 m0, s34, s40
    s_add_u32 s23, s34, s41
    buffer_load_dwordx4 v16, s[44:47], s42 offen offset:0 sc1 lds
    buffer_load_dwordx4 v17, s[44:47], s42 offen offset:1024 sc1 lds
    s_mov_b32 m0, s23
    s_add_u32 s34, s34, 22528
    buffer_load_dwordx4 v19, s[48:51], s42 offen offset:0 sc1 lds
    buffer_load_dwordx4 v20, s[48:51], s42 offen offset:1024 sc1 lds
    buffer_load_dwordx4 v21, s[48:51], s42 offen offset:2048 sc1 lds
    s_add_u32 s42, s42, 128
    s_cmp_ge_u32 s34, 112640
    s_cselect_b32 s34, 0, s34
    s_waitcnt vmcnt(12)
    s_barrier
    s_add_u32 m0, s34, s40
    s_add_u32 s23, s34, s41
    buffer_load_dwordx4 v16, s[44:47], s42 offen offset:0 sc1 lds
    buffer_load_dwordx4 v17, s[44:47], s42 offen offset:1024 sc1 lds
    s_mov_b32 m0, s23
    s_add_u32 s34, s34, 22528
    buffer_load_dwordx4 v19, s[48:51], s42 offen offset:0 sc1 lds
    buffer_load_dwordx4 v20, s[48:51], s42 offen offset:1024 sc1 lds
    buffer_load_dwordx4 v21, s[48:51], s42 offen offset:2048 sc1 lds
    s_add_u32 s42, s42, 128
    s_cmp_ge_u32 s34, 112640
    s_cselect_b32 s34, 0, s34
    s_waitcnt vmcnt(15)
    s_barrier
    s_add_u32 m0, s34, s40
    s_add_u32 s23, s34, s41
    buffer_load_dwordx4 v16, s[44:47], s42 offen offset:0 sc1 lds
    buffer_load_dwordx4 v17, s[44:47], s42 offen offset:1024 sc1 lds
    s_mov_b32 m0, s23
    s_add_u32 s34, s34, 22528
    buffer_load_dwordx4 v19, s[48:51], s42 offen offset:0 sc1 lds
    buffer_load_dwordx4 v20, s[48:51], s42 offen offset:1024 sc1 lds
    buffer_load_dwordx4 v21, s[48:51], s42 offen offset:2048 sc1 lds
    s_add_u32 s42, s42, 128
    s_cmp_ge_u32 s34, 112640
    s_cselect_b32 s34, 0, s34
    s_waitcnt vmcnt(15)
    s_barrier
    s_add_u32 m0, s34, s40
    s_add_u32 s23, s34, s41
    buffer_load_dwordx4 v16, s[44:47], s42 offen offset:0 sc1 lds
    buffer_load_dwordx4 v17, s[44:47], s42 offen offset:1024 sc1 lds
    s_mov_b32 m0, s23
    s_add_u32 s34, s34, 22528
    buffer_load_dwordx4 v19, s[48:51], s42 offen offset:0 sc1 lds
    buffer_load_dwordx4 v20, s[48:51], s42 offen offset:1024 sc1 lds
    buffer_load_dwordx4 v21, s[48:51], s42 offen offset:2048 sc1 lds
    s_add_u32 s42, s42, 128
    s_cmp_ge_u32 s34, 112640
    s_cselect_b32 s34, 0, s34
    s_mov_b32 s35, 6
adaLN_cond__spectral_fnet__mixer_gmlp__prompt_kernel_glY:
    s_waitcnt vmcnt(15)
    s_barrier
    s_add_u32 m0, s34, s40
    s_add_u32 s23, s34, s41
    buffer_load_dwordx4 v16, s[44:47], s42 offen offset:0 sc1 lds
    buffer_load_dwordx4 v17, s[44:47], s42 offen offset:1024 sc1 lds
    s_mov_b32 m0, s23
    s_add_u32 s34, s34, 22528
    buffer_load_dwordx4 v19, s[48:51], s42 offen offset:0 sc1 lds
    buffer_load_dwordx4 v20, s[48:51], s42 offen offset:1024 sc1 lds
    buffer_load_dwordx4 v21, s[48:51], s42 offen offset:2048 sc1 lds
    s_add_u32 s42, s42, 128
    s_cmp_ge_u32 s34, 112640
    s_cselect_b32 s34, 0, s34
    s_add_u32 s35, s35, 1
    s_cmp_le_u32 s35, 27
    s_cbranch_scc1 adaLN_cond__spectral_fnet__mixer_gmlp__prompt_kernel_glY
    s_waitcnt vmcnt(15)
    s_barrier
    s_waitcnt vmcnt(10)
    s_barrier
    s_waitcnt vmcnt(5)
    s_barrier
    s_waitcnt vmcnt(0)
    s_barrier
    s_branch adaLN_cond__spectral_fnet__mixer_gmlp__prompt_kernel_gdone
adaLN_cond__spectral_fnet__mixer_gmlp__prompt_kernel_gdone:
    v_lshrrev_b32 v12, 3, v11
    v_and_b32 v13, 7, v11
    v_bfe_u32 v14, v11, 4, 1
    v_or_b32 v15, 0, v14
    v_lshlrev_b32 v15, 1, v15
    v_xor_b32 v15, v15, v13
    v_lshlrev_b32 v15, 4, v15
    v_lshl_add_u32 v5, v12, 10, v15
    v_or_b32 v15, 2, v14
    v_lshlrev_b32 v15, 1, v15
    v_xor_b32 v15, v15, v13
    v_lshlrev_b32 v15, 4, v15
    v_lshl_add_u32 v6, v12, 10, v15
    v_add_u32 v6, 7168, v6
    v_or_b32 v15, 0, v14
    v_lshlrev_b32 v15, 1, v15
    v_xor_b32 v15, v15, v13
    v_lshlrev_b32 v15, 4, v15
    v_lshl_add_u32 v7, v12, 10, v15
    v_add_u32 v7, 14336, v7
    v_or_b32 v15, 2, v14
    v_lshlrev_b32 v15, 1, v15
    v_xor_b32 v15, v15, v13
    v_lshlrev_b32 v15, 4, v15
    v_lshl_add_u32 v8, v12, 10, v15
    v_add_u32 v8, 21504, v8
    v_xor_b32 v13, v13, v12
    v_lshlrev_b32 v13, 4, v13
    s_and_b32 s23, s29, 1
    s_lshl_b32 s23, s23, 5
    v_add_u32 v14, s23, v12
    v_mul_u32_u24 v16, 1792, v14
    s_lshr_b32 s24, s29, 1
    s_lshl_b32 s24, s24, 7
    v_add3_u32 v16, v16, v13, s24
    v_add_u32 v17, 13312, v16
    v_add_u32 v18, 26624, v16
    v_add_u32 v19, 39936, v16
    s_lshl_b32 s23, s29, 4
    v_add_u32 v14, s23, v12
    v_lshl_add_u32 v20, v14, 10, v13
    v_add_u32 v21, 7168, v20
    s_mov_b32 s18, 917504
    s_mov_b32 s19, 0x20000
    s_lshl_b32 s30, s29, 15
    s_lshl_b32 s23, s22, 7
    s_add_u32 s30, s30, s23
    s_lshl_b32 s32, s29, 12
    s_mul_i32 s31, s21, 114688
    s_add_u32 s31, s31, 25165824
    s_lshl_b32 s33, s29, 12
    s_add_u32 s33, s33, 81920
    s_lshl_b32 s40, s21, 16
    s_add_u32 s40, s40, s23
    s_add_u32 s40, s40, 8388608
    s_barrier
    s_add_u32 m0, s32, 0
    s_add_u32 s23, s30, 0
    buffer_load_dwordx4 v5, s[16:19], s23 offen offset:0 lds
    buffer_load_dwordx4 v6, s[16:19], s23 offen offset:1024 lds
    buffer_load_dwordx4 v7, s[16:19], s23 offen offset:2048 lds
    buffer_load_dwordx4 v8, s[16:19], s23 offen offset:3072 lds
    s_add_u32 m0, s32, 16384
    s_add_u32 s23, s30, 131072
    buffer_load_dwordx4 v5, s[16:19], s23 offen offset:0 lds
    buffer_load_dwordx4 v6, s[16:19], s23 offen offset:1024 lds
    buffer_load_dwordx4 v7, s[16:19], s23 offen offset:2048 lds
    buffer_load_dwordx4 v8, s[16:19], s23 offen offset:3072 lds
    s_add_u32 m0, s32, 32768
    s_add_u32 s23, s30, 262144
    buffer_load_dwordx4 v5, s[16:19], s23 offen offset:0 lds
    buffer_load_dwordx4 v6, s[16:19], s23 offen offset:1024 lds
    buffer_load_dwordx4 v7, s[16:19], s23 offen offset:2048 lds
    buffer_load_dwordx4 v8, s[16:19], s23 offen offset:3072 lds
    s_add_u32 m0, s32, 49152
    s_add_u32 s23, s30, 393216
    buffer_load_dwordx4 v5, s[16:19], s23 offen offset:0 lds
    buffer_load_dwordx4 v6, s[16:19], s23 offen offset:1024 lds
    buffer_load_dwordx4 v7, s[16:19], s23 offen offset:2048 lds
    buffer_load_dwordx4 v8, s[16:19], s23 offen offset:3072 lds
    s_add_u32 m0, s32, 65536
    s_add_u32 s23, s30, 524288
    buffer_load_dwordx4 v5, s[16:19], s23 offen offset:0 lds
    buffer_load_dwordx4 v6, s[16:19], s23 offen offset:1024 lds
    buffer_load_dwordx4 v7, s[16:19], s23 offen offset:2048 lds
    buffer_load_dwordx4 v8, s[16:19], s23 offen offset:3072 lds
    s_lshl_b32 s25, s21, 10
    s_add_u32 s25, s25, 413696
    s_cmp_lg_u32 s20, 4
    s_cbranch_scc1 adaLN_cond__spectral_fnet__mixer_gmlp__prompt_kernel_dt
    v_and_b32 v244, 63, v0
    v_and_b32 v244, 7, v244
    v_lshl_add_u32 v244, v244, 7, s25
    s_mov_b32 s28, 0
adaLN_cond__spectral_fnet__mixer_gmlp__prompt_kernel_wt:
    global_load_dword v248, v244, s[4:5] sc1
    s_waitcnt vmcnt(0)
    v_xor_b32 v248, s64, v248
    v_cmp_ne_u32 vcc, 0, v248
    s_add_u32 s28, s28, 1
    s_cmp_eq_u64 vcc, 0
    s_cbranch_scc1 adaLN_cond__spectral_fnet__mixer_gmlp__prompt_kernel_dt
    s_sleep 1
    s_cmp_lt_u32 s28, 262144
    s_cbranch_scc1 adaLN_cond__spectral_fnet__mixer_gmlp__prompt_kernel_wt
adaLN_cond__spectral_fnet__mixer_gmlp__prompt_kernel_dt:
    s_barrier
    s_add_u32 m0, s33, 0
    s_add_u32 s23, s31, 0
    buffer_load_dwordx4 v16, s[4:7], s23 offen offset:0 sc1 lds
    buffer_load_dwordx4 v17, s[4:7], s23 offen offset:1024 sc1 lds
    buffer_load_dwordx4 v18, s[4:7], s23 offen offset:2048 sc1 lds
    buffer_load_dwordx4 v19, s[4:7], s23 offen offset:3072 sc1 lds
    s_add_u32 m0, s33, 16384
    s_add_u32 s23, s31, 256
    buffer_load_dwordx4 v16, s[4:7], s23 offen offset:0 sc1 lds
    buffer_load_dwordx4 v17, s[4:7], s23 offen offset:1024 sc1 lds
    buffer_load_dwordx4 v18, s[4:7], s23 offen offset:2048 sc1 lds
    buffer_load_dwordx4 v19, s[4:7], s23 offen offset:3072 sc1 lds
    s_add_u32 m0, s33, 32768
    s_add_u32 s23, s31, 512
    buffer_load_dwordx4 v16, s[4:7], s23 offen offset:0 sc1 lds
    buffer_load_dwordx4 v17, s[4:7], s23 offen offset:1024 sc1 lds
    buffer_load_dwordx4 v18, s[4:7], s23 offen offset:2048 sc1 lds
    buffer_load_dwordx4 v19, s[4:7], s23 offen offset:3072 sc1 lds
    s_add_u32 m0, s33, 49152
    s_add_u32 s23, s31, 768
    buffer_load_dwordx4 v16, s[4:7], s23 offen offset:0 sc1 lds
    buffer_load_dwordx4 v17, s[4:7], s23 offen offset:1024 sc1 lds
    buffer_load_dwordx4 v18, s[4:7], s23 offen offset:2048 sc1 lds
    buffer_load_dwordx4 v19, s[4:7], s23 offen offset:3072 sc1 lds
    s_add_u32 m0, s33, 65536
    s_add_u32 s23, s31, 1024
    buffer_load_dwordx4 v16, s[4:7], s23 offen offset:0 sc1 lds
    buffer_load_dwordx4 v17, s[4:7], s23 offen offset:1024 sc1 lds
    buffer_load_dwordx4 v18, s[4:7], s23 offen offset:2048 sc1 lds
    buffer_load_dwordx4 v19, s[4:7], s23 offen offset:3072 sc1 lds
    s_waitcnt vmcnt(16)
    s_barrier
    s_waitcnt vmcnt(12)
    s_barrier
    s_add_u32 m0, s32, 0
    s_add_u32 s23, s30, 655360
    buffer_load_dwordx4 v5, s[16:19], s23 offen offset:0 lds
    buffer_load_dwordx4 v6, s[16:19], s23 offen offset:1024 lds
    buffer_load_dwordx4 v7, s[16:19], s23 offen offset:2048 lds
    buffer_load_dwordx4 v8, s[16:19], s23 offen offset:3072 lds
    s_add_u32 m0, s33, 0
    s_add_u32 s23, s31, 1280
    buffer_load_dwordx4 v16, s[4:7], s23 offen offset:0 sc1 lds
    buffer_load_dwordx4 v17, s[4:7], s23 offen offset:1024 sc1 lds
    buffer_load_dwordx4 v18, s[4:7], s23 offen offset:2048 sc1 lds
    buffer_load_dwordx4 v19, s[4:7], s23 offen offset:3072 sc1 lds
    s_waitcnt vmcnt(16)
    s_barrier
    s_add_u32 m0, s32, 16384
    s_add_u32 s23, s30, 786432
    buffer_load_dwordx4 v5, s[16:19], s23 offen offset:0 lds
    buffer_load_dwordx4 v6, s[16:19], s23 offen offset:1024 lds
    buffer_load_dwordx4 v7, s[16:19], s23 offen offset:2048 lds
    buffer_load_dwordx4 v8, s[16:19], s23 offen offset:3072 lds
    s_add_u32 m0, s33, 16384
    s_add_u32 s23, s31, 1536
    buffer_load_dwordx4 v16, s[4:7], s23 offen offset:0 sc1 lds
    buffer_load_dwordx4 v17, s[4:7], s23 offen offset:1024 sc1 lds
    buffer_load_dwordx4 v18, s[4:7], s23 offen offset:2048 sc1 lds
    buffer_load_dwordx4 v19, s[4:7], s23 offen offset:3072 sc1 lds
    s_waitcnt vmcnt(20)
    s_barrier
    s_lshl_b32 s23, s29, 11
    s_add_u32 m0, s23, 114688
    s_nop 0
    buffer_load_dwordx4 v20, s[4:7], s40 offen offset:0 sc1 lds
    buffer_load_dwordx4 v21, s[4:7], s40 offen offset:1024 sc1 lds
    s_waitcnt vmcnt(18)
    s_barrier
    s_waitcnt vmcnt(10)
    s_barrier
    s_waitcnt vmcnt(2)
    s_barrier
    s_waitcnt vmcnt(0)
    s_barrier
    s_endpgm
adaLN_cond__spectral_fnet__mixer_gmlp__prompt_kernel_end:
    s_endpgm
code_end:
.section .rodata,"a"
.p2align 6
.amdhsa_kernel adaLN_cond__spectral_fnet__mixer_gmlp__prompt_kernel
  .amdhsa_next_free_vgpr 256
  .amdhsa_next_free_sgpr 68
  .amdhsa_accum_offset 256
  .amdhsa_group_segment_fixed_size 0
  .amdhsa_kernarg_size 120
  .amdhsa_user_sgpr_count 2
  .amdhsa_user_sgpr_kernarg_segment_ptr 1
  .amdhsa_system_sgpr_workgroup_id_x 1
  .amdhsa_float_denorm_mode_32 3
.end_amdhsa_kernel
.p2align 8
.type fft_tables,@object
fft_tables:
.long 0x3f803f80, 0x3f803f80, 0x3f803f80, 0x3f803f80, 0x3f7f3f80, 0x3f753f7b, 0x3f623f6d, 0x3f463f55
.long 0x3f7b3f80, 0x3f553f6d, 0x3f0e3f35, 0x3e483ec4, 0x3f753f80, 0x3f223f55, 0x3dc93ec4, 0xbef1be48
.long 0x3f6d3f80, 0x3ec43f35, 0xbec40000, 0xbf6dbf35, 0x3f623f80, 0x3dc93f0e, 0xbf46bec4, 0xbf75bf7b
.long 0x3f553f80, 0xbe483ec4, 0xbf7bbf35, 0xbf0ebf6d, 0x3f463f80, 0xbef13e48, 0xbf75bf6d, 0x3dc9bf0e
.long 0x3f353f80, 0xbf350000, 0xbf35bf80, 0x3f350000, 0x3f223f80, 0xbf62be48, 0xbe95bf6d, 0x3f7f3f0e
.long 0x3f0e3f80, 0xbf7bbec4, 0x3e48bf35, 0x3f553f6d, 0x3ef13f80, 0xbf7fbf0e, 0x3f22bec4, 0x3e953f7b
.long 0x3ec43f80, 0xbf6dbf35, 0x3f6d0000, 0xbec43f35, 0x3e953f80, 0xbf46bf55, 0x3f7f3ec4, 0xbf623e48
.long 0x3e483f80, 0xbf0ebf6d, 0x3f553f35, 0xbf7bbec4, 0x3dc93f80, 0xbe95bf7b, 0x3ef13f6d, 0xbf22bf55
.long 0x3f803f80, 0x3f803f80, 0x3f803f80, 0x3f803f80, 0x3f223f35, 0x3ef13f0e, 0x3e953ec4, 0x3dc93e48
.long 0xbe480000, 0xbf0ebec4, 0xbf55bf35, 0xbf7bbf6d, 0xbf62bf35, 0xbf7fbf7b, 0xbf46bf6d, 0xbe95bf0e
.long 0xbf6dbf80, 0xbec4bf35, 0x3ec40000, 0x3f6d3f35, 0xbe95bf35, 0x3f223e48, 0x3f7f3f6d, 0x3ef13f55
.long 0x3f0e0000, 0x3f7b3f6d, 0x3e483f35, 0xbf55bec4, 0x3f7f3f35, 0x3e953f55, 0xbf62bec4, 0xbf22bf7b
.long 0x3f353f80, 0xbf350000, 0xbf35bf80, 0x3f350000, 0xbdc93f35, 0xbf75bf55, 0x3ef1bec4, 0x3f463f7b
.long 0xbf550000, 0xbe48bf6d, 0x3f7b3f35, 0xbf0e3ec4, 0xbf75bf35, 0x3f46be48, 0x3dc93f6d, 0xbf62bf55
.long 0xbec4bf80, 0x3f6d3f35, 0xbf6d0000, 0x3ec4bf35, 0x3ef1bf35, 0x3dc93f7b, 0xbf22bf6d, 0x3f753f0e
.long 0x3f7b0000, 0xbf553ec4, 0x3f0ebf35, 0xbe483f6d, 0x3f463f35, 0xbf62bf0e, 0x3f753ec4, 0xbf7fbe48
.long 0x3f803f80, 0x3f803f80, 0x3f803f80, 0x3f803f80, 0xbdc90000, 0xbe95be48, 0xbef1bec4, 0xbf22bf0e
.long 0xbf7bbf80, 0xbf55bf6d, 0xbf0ebf35, 0xbe48bec4, 0x3e950000, 0x3f463f0e, 0x3f7f3f6d, 0x3f623f7b
.long 0x3f6d3f80, 0x3ec43f35, 0xbec40000, 0xbf6dbf35, 0xbef10000, 0xbf7fbf55, 0xbf22bf6d, 0x3e95be48
.long 0xbf55bf80, 0x3e48bec4, 0x3f7b3f35, 0x3f0e3f6d, 0x3f220000, 0x3f623f7b, 0xbe953ec4, 0xbf7fbf55
.long 0x3f353f80, 0xbf350000, 0xbf35bf80, 0x3f350000, 0xbf460000, 0xbef1bf7b, 0x3f753ec4, 0x3dc93f55
.long 0xbf0ebf80, 0x3f7b3ec4, 0xbe483f35, 0xbf55bf6d, 0x3f620000, 0xbdc93f55, 0xbf46bf6d, 0x3f753e48
.long 0x3ec43f80, 0xbf6dbf35, 0x3f6d0000, 0xbec43f35, 0xbf750000, 0x3f22bf0e, 0xbdc93f6d, 0xbef1bf7b
.long 0xbe48bf80, 0x3f0e3f6d, 0xbf55bf35, 0x3f7b3ec4, 0x3f7f0000, 0xbf753e48, 0x3f62bec4, 0xbf463f0e
.long 0x3f803f80, 0x3f803f80, 0x3f803f80, 0x3f803f80, 0xbf46bf35, 0xbf62bf55, 0xbf75bf6d, 0xbf7fbf7b
.long 0x3e480000, 0x3f0e3ec4, 0x3f553f35, 0x3f7b3f6d, 0x3ef13f35, 0xbdc93e48, 0xbf22bec4, 0xbf75bf55
.long 0xbf6dbf80, 0xbec4bf35, 0x3ec40000, 0x3f6d3f35, 0x3f753f35, 0x3f463f7b, 0xbdc93ec4, 0xbf62bf0e
.long 0xbf0e0000, 0xbf7bbf6d, 0xbe48bf35, 0x3f553ec4, 0xbdc9bf35, 0x3f753f0e, 0x3ef13f6d, 0xbf46be48
.long 0x3f353f80, 0xbf350000, 0xbf35bf80, 0x3f350000, 0xbf7fbf35, 0x3e95bf0e, 0x3f623f6d, 0xbf223e48
.long 0x3f550000, 0x3e483f6d, 0xbf7bbf35, 0x3f0ebec4, 0xbe953f35, 0xbf22bf7b, 0x3f7f3ec4, 0xbef13f0e
.long 0xbec4bf80, 0x3f6d3f35, 0xbf6d0000, 0x3ec4bf35, 0x3f623f35, 0xbf7fbe48, 0x3f46bec4, 0xbe953f55
.long 0xbf7b0000, 0x3f55bec4, 0xbf0e3f35, 0x3e48bf6d, 0x3f22bf35, 0xbef13f55, 0x3e95bf6d, 0xbdc93f7b
.long 0x3f803f80, 0x3f803f80, 0x3f803f80, 0x3f803f80, 0xbf7fbf80, 0xbf75bf7b, 0xbf62bf6d, 0xbf46bf55
.long 0x3f7b3f80, 0x3f553f6d, 0x3f0e3f35, 0x3e483ec4, 0xbf75bf80, 0xbf22bf55, 0xbdc9bec4, 0x3ef13e48
.long 0x3f6d3f80, 0x3ec43f35, 0xbec40000, 0xbf6dbf35, 0xbf62bf80, 0xbdc9bf0e, 0x3f463ec4, 0x3f753f7b
.long 0x3f553f80, 0xbe483ec4, 0xbf7bbf35, 0xbf0ebf6d, 0xbf46bf80, 0x3ef1be48, 0x3f753f6d, 0xbdc93f0e
.long 0x3f353f80, 0xbf350000, 0xbf35bf80, 0x3f350000, 0xbf22bf80, 0x3f623e48, 0x3e953f6d, 0xbf7fbf0e
.long 0x3f0e3f80, 0xbf7bbec4, 0x3e48bf35, 0x3f553f6d, 0xbef1bf80, 0x3f7f3f0e, 0xbf223ec4, 0xbe95bf7b
.long 0x3ec43f80, 0xbf6dbf35, 0x3f6d0000, 0xbec43f35, 0xbe95bf80, 0x3f463f55, 0xbf7fbec4, 0x3f62be48
.long 0x3e483f80, 0xbf0ebf6d, 0x3f553f35, 0xbf7bbec4, 0xbdc9bf80, 0x3e953f7b, 0xbef1bf6d, 0x3f223f55
.long 0x3f803f80, 0x3f803f80, 0x3f803f80, 0x3f803f80, 0xbf22bf35, 0xbef1bf0e, 0xbe95bec4, 0xbdc9be48
.long 0xbe480000, 0xbf0ebec4, 0xbf55bf35, 0xbf7bbf6d, 0x3f623f35, 0x3f7f3f7b, 0x3f463f6d, 0x3e953f0e
.long 0xbf6dbf80, 0xbec4bf35, 0x3ec40000, 0x3f6d3f35, 0x3e953f35, 0xbf22be48, 0xbf7fbf6d, 0xbef1bf55
.long 0x3f0e0000, 0x3f7b3f6d, 0x3e483f35, 0xbf55bec4, 0xbf7fbf35, 0xbe95bf55, 0x3f623ec4, 0x3f223f7b
.long 0x3f353f80, 0xbf350000, 0xbf35bf80, 0x3f350000, 0x3dc9bf35, 0x3f753f55, 0xbef13ec4, 0xbf46bf7b
.long 0xbf550000, 0xbe48bf6d, 0x3f7b3f35, 0xbf0e3ec4, 0x3f753f35, 0xbf463e48, 0xbdc9bf6d, 0x3f623f55
.long 0xbec4bf80, 0x3f6d3f35, 0xbf6d0000, 0x3ec4bf35, 0xbef13f35, 0xbdc9bf7b, 0x3f223f6d, 0xbf75bf0e
.long 0x3f7b0000, 0xbf553ec4, 0x3f0ebf35, 0xbe483f6d, 0xbf46bf35, 0x3f623f0e, 0xbf75bec4, 0x3f7f3e48
.long 0x3f803f80, 0x3f803f80, 0x3f803f80, 0x3f803f80, 0x3dc90000, 0x3e953e48, 0x3ef13ec4, 0x3f223f0e
.long 0xbf7bbf80, 0xbf55bf6d, 0xbf0ebf35, 0xbe48bec4, 0xbe950000, 0xbf46bf0e, 0xbf7fbf6d, 0xbf62bf7b
.long 0x3f6d3f80, 0x3ec43f35, 0xbec40000, 0xbf6dbf35, 0x3ef10000, 0x3f7f3f55, 0x3f223f6d, 0xbe953e48
.long 0xbf55bf80, 0x3e48bec4, 0x3f7b3f35, 0x3f0e3f6d, 0xbf220000, 0xbf62bf7b, 0x3e95bec4, 0x3f7f3f55
.long 0x3f353f80, 0xbf350000, 0xbf35bf80, 0x3f350000, 0x3f460000, 0x3ef13f7b, 0xbf75bec4, 0xbdc9bf55
.long 0xbf0ebf80, 0x3f7b3ec4, 0xbe483f35, 0xbf55bf6d, 0xbf620000, 0x3dc9bf55, 0x3f463f6d, 0xbf75be48
.long 0x3ec43f80, 0xbf6dbf35, 0x3f6d0000, 0xbec43f35, 0x3f750000, 0xbf223f0e, 0x3dc9bf6d, 0x3ef13f7b
.long 0xbe48bf80, 0x3f0e3f6d, 0xbf55bf35, 0x3f7b3ec4, 0xbf7f0000, 0x3f75be48, 0xbf623ec4, 0x3f46bf0e
.long 0x3f803f80, 0x3f803f80, 0x3f803f80, 0x3f803f80, 0x3f463f35, 0x3f623f55, 0x3f753f6d, 0x3f7f3f7b
.long 0x3e480000, 0x3f0e3ec4, 0x3f553f35, 0x3f7b3f6d, 0xbef1bf35, 0x3dc9be48, 0x3f223ec4, 0x3f753f55
.long 0xbf6dbf80, 0xbec4bf35, 0x3ec40000, 0x3f6d3f35, 0xbf75bf35, 0xbf46bf7b, 0x3dc9bec4, 0x3f623f0e
.long 0xbf0e0000, 0xbf7bbf6d, 0xbe48bf35, 0x3f553ec4, 0x3dc93f35, 0xbf75bf0e, 0xbef1bf6d, 0x3f463e48
.long 0x3f353f80, 0xbf350000, 0xbf35bf80, 0x3f350000, 0x3f7f3f35, 0xbe953f0e, 0xbf62bf6d, 0x3f22be48
.long 0x3f550000, 0x3e483f6d, 0xbf7bbf35, 0x3f0ebec4, 0x3e95bf35, 0x3f223f7b, 0xbf7fbec4, 0x3ef1bf0e
.long 0xbec4bf80, 0x3f6d3f35, 0xbf6d0000, 0x3ec4bf35, 0xbf62bf35, 0x3f7f3e48, 0xbf463ec4, 0x3e95bf55
.long 0xbf7b0000, 0x3f55bec4, 0xbf0e3f35, 0x3e48bf6d, 0xbf223f35, 0x3ef1bf55, 0xbe953f6d, 0x3dc9bf7b
.long 0x00003f80, 0x0000bf80, 0x00003f80, 0x0000bf80, 0xbdc93f80, 0x3e95bf7b, 0xbef13f6d, 0x3f22bf55
.long 0xbe483f80, 0x3f0ebf6d, 0xbf553f35, 0x3f7bbec4, 0xbe953f80, 0x3f46bf55, 0xbf7f3ec4, 0x3f623e48
.long 0xbec43f80, 0x3f6dbf35, 0xbf6d0000, 0x3ec43f35, 0xbef13f80, 0x3f7fbf0e, 0xbf22bec4, 0xbe953f7b
.long 0xbf0e3f80, 0x3f7bbec4, 0xbe48bf35, 0xbf553f6d, 0xbf223f80, 0x3f62be48, 0x3e95bf6d, 0xbf7f3f0e
.long 0xbf353f80, 0x3f350000, 0x3f35bf80, 0xbf350000, 0xbf463f80, 0x3ef13e48, 0x3f75bf6d, 0xbdc9bf0e
.long 0xbf553f80, 0x3e483ec4, 0x3f7bbf35, 0x3f0ebf6d, 0xbf623f80, 0xbdc93f0e, 0x3f46bec4, 0x3f75bf7b
.long 0xbf6d3f80, 0xbec43f35, 0x3ec40000, 0x3f6dbf35, 0xbf753f80, 0xbf223f55, 0xbdc93ec4, 0x3ef1be48
.long 0xbf7b3f80, 0xbf553f6d, 0xbf0e3f35, 0xbe483ec4, 0xbf7f3f80, 0xbf753f7b, 0xbf623f6d, 0xbf463f55
.long 0x00003f80, 0x0000bf80, 0x00003f80, 0x0000bf80, 0xbf463f35, 0x3f62bf0e, 0xbf753ec4, 0x3f7fbe48
.long 0xbf7b0000, 0x3f553ec4, 0xbf0ebf35, 0x3e483f6d, 0xbef1bf35, 0xbdc93f7b, 0x3f22bf6d, 0xbf753f0e
.long 0x3ec4bf80, 0xbf6d3f35, 0x3f6d0000, 0xbec4bf35, 0x3f75bf35, 0xbf46be48, 0xbdc93f6d, 0x3f62bf55
.long 0x3f550000, 0x3e48bf6d, 0xbf7b3f35, 0x3f0e3ec4, 0x3dc93f35, 0x3f75bf55, 0xbef1bec4, 0xbf463f7b
.long 0xbf353f80, 0x3f350000, 0x3f35bf80, 0xbf350000, 0xbf7f3f35, 0xbe953f55, 0x3f62bec4, 0x3f22bf7b
.long 0xbf0e0000, 0xbf7b3f6d, 0xbe483f35, 0x3f55bec4, 0x3e95bf35, 0xbf223e48, 0xbf7f3f6d, 0xbef13f55
.long 0x3f6dbf80, 0x3ec4bf35, 0xbec40000, 0xbf6d3f35, 0x3f62bf35, 0x3f7fbf7b, 0x3f46bf6d, 0x3e95bf0e
.long 0x3e480000, 0x3f0ebec4, 0x3f55bf35, 0x3f7bbf6d, 0xbf223f35, 0xbef13f0e, 0xbe953ec4, 0xbdc93e48
.long 0x00003f80, 0x0000bf80, 0x00003f80, 0x0000bf80, 0xbf7f0000, 0x3f753e48, 0xbf62bec4, 0x3f463f0e
.long 0x3e48bf80, 0xbf0e3f6d, 0x3f55bf35, 0xbf7b3ec4, 0x3f750000, 0xbf22bf0e, 0x3dc93f6d, 0x3ef1bf7b
.long 0xbec43f80, 0x3f6dbf35, 0xbf6d0000, 0x3ec43f35, 0xbf620000, 0x3dc93f55, 0x3f46bf6d, 0xbf753e48
.long 0x3f0ebf80, 0xbf7b3ec4, 0x3e483f35, 0x3f55bf6d, 0x3f460000, 0x3ef1bf7b, 0xbf753ec4, 0xbdc93f55
.long 0xbf353f80, 0x3f350000, 0x3f35bf80, 0xbf350000, 0xbf220000, 0xbf623f7b, 0x3e953ec4, 0x3f7fbf55
.long 0x3f55bf80, 0xbe48bec4, 0xbf7b3f35, 0xbf0e3f6d, 0x3ef10000, 0x3f7fbf55, 0x3f22bf6d, 0xbe95be48
.long 0xbf6d3f80, 0xbec43f35, 0x3ec40000, 0x3f6dbf35, 0xbe950000, 0xbf463f0e, 0xbf7f3f6d, 0xbf623f7b
.long 0x3f7bbf80, 0x3f55bf6d, 0x3f0ebf35, 0x3e48bec4, 0x3dc90000, 0x3e95be48, 0x3ef1bec4, 0x3f22bf0e
.long 0x00003f80, 0x0000bf80, 0x00003f80, 0x0000bf80, 0xbf22bf35, 0x3ef13f55, 0xbe95bf6d, 0x3dc93f7b
.long 0x3f7b0000, 0xbf55bec4, 0x3f0e3f35, 0xbe48bf6d, 0xbf623f35, 0x3f7fbe48, 0xbf46bec4, 0x3e953f55
.long 0x3ec4bf80, 0xbf6d3f35, 0x3f6d0000, 0xbec4bf35, 0x3e953f35, 0x3f22bf7b, 0xbf7f3ec4, 0x3ef13f0e
.long 0xbf550000, 0xbe483f6d, 0x3f7bbf35, 0xbf0ebec4, 0x3f7fbf35, 0xbe95bf0e, 0xbf623f6d, 0x3f223e48
.long 0xbf353f80, 0x3f350000, 0x3f35bf80, 0xbf350000, 0x3dc9bf35, 0xbf753f0e, 0xbef13f6d, 0x3f46be48
.long 0x3f0e0000, 0x3f7bbf6d, 0x3e48bf35, 0xbf553ec4, 0xbf753f35, 0xbf463f7b, 0x3dc93ec4, 0x3f62bf0e
.long 0x3f6dbf80, 0x3ec4bf35, 0xbec40000, 0xbf6d3f35, 0xbef13f35, 0x3dc93e48, 0x3f22bec4, 0x3f75bf55
.long 0xbe480000, 0xbf0e3ec4, 0xbf553f35, 0xbf7b3f6d, 0x3f46bf35, 0x3f62bf55, 0x3f75bf6d, 0x3f7fbf7b
.long 0x00003f80, 0x0000bf80, 0x00003f80, 0x0000bf80, 0x3dc9bf80, 0xbe953f7b, 0x3ef1bf6d, 0xbf223f55
.long 0xbe483f80, 0x3f0ebf6d, 0xbf553f35, 0x3f7bbec4, 0x3e95bf80, 0xbf463f55, 0x3f7fbec4, 0xbf62be48
.long 0xbec43f80, 0x3f6dbf35, 0xbf6d0000, 0x3ec43f35, 0x3ef1bf80, 0xbf7f3f0e, 0x3f223ec4, 0x3e95bf7b
.long 0xbf0e3f80, 0x3f7bbec4, 0xbe48bf35, 0xbf553f6d, 0x3f22bf80, 0xbf623e48, 0xbe953f6d, 0x3f7fbf0e
.long 0xbf353f80, 0x3f350000, 0x3f35bf80, 0xbf350000, 0x3f46bf80, 0xbef1be48, 0xbf753f6d, 0x3dc93f0e
.long 0xbf553f80, 0x3e483ec4, 0x3f7bbf35, 0x3f0ebf6d, 0x3f62bf80, 0x3dc9bf0e, 0xbf463ec4, 0xbf753f7b
.long 0xbf6d3f80, 0xbec43f35, 0x3ec40000, 0x3f6dbf35, 0x3f75bf80, 0x3f22bf55, 0x3dc9bec4, 0xbef13e48
.long 0xbf7b3f80, 0xbf553f6d, 0xbf0e3f35, 0xbe483ec4, 0x3f7fbf80, 0x3f75bf7b, 0x3f62bf6d, 0x3f46bf55
.long 0x00003f80, 0x0000bf80, 0x00003f80, 0x0000bf80, 0x3f46bf35, 0xbf623f0e, 0x3f75bec4, 0xbf7f3e48
.long 0xbf7b0000, 0x3f553ec4, 0xbf0ebf35, 0x3e483f6d, 0x3ef13f35, 0x3dc9bf7b, 0xbf223f6d, 0x3f75bf0e
.long 0x3ec4bf80, 0xbf6d3f35, 0x3f6d0000, 0xbec4bf35, 0xbf753f35, 0x3f463e48, 0x3dc9bf6d, 0xbf623f55
.long 0x3f550000, 0x3e48bf6d, 0xbf7b3f35, 0x3f0e3ec4, 0xbdc9bf35, 0xbf753f55, 0x3ef13ec4, 0x3f46bf7b
.long 0xbf353f80, 0x3f350000, 0x3f35bf80, 0xbf350000, 0x3f7fbf35, 0x3e95bf55, 0xbf623ec4, 0xbf223f7b
.long 0xbf0e0000, 0xbf7b3f6d, 0xbe483f35, 0x3f55bec4, 0xbe953f35, 0x3f22be48, 0x3f7fbf6d, 0x3ef1bf55
.long 0x3f6dbf80, 0x3ec4bf35, 0xbec40000, 0xbf6d3f35, 0xbf623f35, 0xbf7f3f7b, 0xbf463f6d, 0xbe953f0e
.long 0x3e480000, 0x3f0ebec4, 0x3f55bf35, 0x3f7bbf6d, 0x3f22bf35, 0x3ef1bf0e, 0x3e95bec4, 0x3dc9be48
.long 0x00003f80, 0x0000bf80, 0x00003f80, 0x0000bf80, 0x3f7f0000, 0xbf75be48, 0x3f623ec4, 0xbf46bf0e
.long 0x3e48bf80, 0xbf0e3f6d, 0x3f55bf35, 0xbf7b3ec4, 0xbf750000, 0x3f223f0e, 0xbdc9bf6d, 0xbef13f7b
.long 0xbec43f80, 0x3f6dbf35, 0xbf6d0000, 0x3ec43f35, 0x3f620000, 0xbdc9bf55, 0xbf463f6d, 0x3f75be48
.long 0x3f0ebf80, 0xbf7b3ec4, 0x3e483f35, 0x3f55bf6d, 0xbf460000, 0xbef13f7b, 0x3f75bec4, 0x3dc9bf55
.long 0xbf353f80, 0x3f350000, 0x3f35bf80, 0xbf350000, 0x3f220000, 0x3f62bf7b, 0xbe95bec4, 0xbf7f3f55
.long 0x3f55bf80, 0xbe48bec4, 0xbf7b3f35, 0xbf0e3f6d, 0xbef10000, 0xbf7f3f55, 0xbf223f6d, 0x3e953e48
.long 0xbf6d3f80, 0xbec43f35, 0x3ec40000, 0x3f6dbf35, 0x3e950000, 0x3f46bf0e, 0x3f7fbf6d, 0x3f62bf7b
.long 0x3f7bbf80, 0x3f55bf6d, 0x3f0ebf35, 0x3e48bec4, 0xbdc90000, 0xbe953e48, 0xbef13ec4, 0xbf223f0e
.long 0x00003f80, 0x0000bf80, 0x00003f80, 0x0000bf80, 0x3f223f35, 0xbef1bf55, 0x3e953f6d, 0xbdc9bf7b
.long 0x3f7b0000, 0xbf55bec4, 0x3f0e3f35, 0xbe48bf6d, 0x3f62bf35, 0xbf7f3e48, 0x3f463ec4, 0xbe95bf55
.long 0x3ec4bf80, 0xbf6d3f35, 0x3f6d0000, 0xbec4bf35, 0xbe95bf35, 0xbf223f7b, 0x3f7fbec4, 0xbef1bf0e
.long 0xbf550000, 0xbe483f6d, 0x3f7bbf35, 0xbf0ebec4, 0xbf7f3f35, 0x3e953f0e, 0x3f62bf6d, 0xbf22be48
.long 0xbf353f80, 0x3f350000, 0x3f35bf80, 0xbf350000, 0xbdc93f35, 0x3f75bf0e, 0x3ef1bf6d, 0xbf463e48
.long 0x3f0e0000, 0x3f7bbf6d, 0x3e48bf35, 0xbf553ec4, 0x3f75bf35, 0x3f46bf7b, 0xbdc9bec4, 0xbf623f0e
.long 0x3f6dbf80, 0x3ec4bf35, 0xbec40000, 0xbf6d3f35, 0x3ef1bf35, 0xbdc9be48, 0xbf223ec4, 0xbf753f55
.long 0xbe480000, 0xbf0e3ec4, 0xbf553f35, 0xbf7b3f6d, 0xbf463f35, 0xbf623f55, 0xbf753f6d, 0xbf7f3f7b
.long 0xbf803f80, 0xbf803f80, 0xbf803f80, 0xbf803f80, 0xbdc98000, 0xbe95be48, 0xbef1bec4, 0xbf22bf0e
.long 0xbe488000, 0xbf0ebec4, 0xbf55bf35, 0xbf7bbf6d, 0xbe958000, 0xbf46bf0e, 0xbf7fbf6d, 0xbf62bf7b
.long 0xbec48000, 0xbf6dbf35, 0xbf6dbf80, 0xbec4bf35, 0xbef18000, 0xbf7fbf55, 0xbf22bf6d, 0x3e95be48
.long 0xbf0e8000, 0xbf7bbf6d, 0xbe48bf35, 0x3f553ec4, 0xbf228000, 0xbf62bf7b, 0x3e95bec4, 0x3f7f3f55
.long 0xbf358000, 0xbf35bf80, 0x3f358000, 0x3f353f80, 0xbf468000, 0xbef1bf7b, 0x3f753ec4, 0x3dc93f55
.long 0xbf558000, 0xbe48bf6d, 0x3f7b3f35, 0xbf0e3ec4, 0xbf628000, 0x3dc9bf55, 0x3f463f6d, 0xbf75be48
.long 0xbf6d8000, 0x3ec4bf35, 0x3ec43f80, 0xbf6dbf35, 0xbf758000, 0x3f22bf0e, 0xbdc93f6d, 0xbef1bf7b
.long 0xbf7b8000, 0x3f55bec4, 0xbf0e3f35, 0x3e48bf6d, 0xbf7f8000, 0x3f75be48, 0xbf623ec4, 0x3f46bf0e
.long 0xbf803f80, 0xbf803f80, 0xbf803f80, 0xbf803f80, 0xbf46bf35, 0xbf62bf55, 0xbf75bf6d, 0xbf7fbf7b
.long 0xbf7bbf80, 0xbf55bf6d, 0xbf0ebf35, 0xbe48bec4, 0xbef1bf35, 0x3dc9be48, 0x3f223ec4, 0x3f753f55
.long 0x3ec48000, 0x3f6d3f35, 0x3f6d3f80, 0x3ec43f35, 0x3f753f35, 0x3f463f7b, 0xbdc93ec4, 0xbf62bf0e
.long 0x3f553f80, 0xbe483ec4, 0xbf7bbf35, 0xbf0ebf6d, 0x3dc93f35, 0xbf75bf0e, 0xbef1bf6d, 0x3f463e48
.long 0xbf358000, 0xbf35bf80, 0x3f358000, 0x3f353f80, 0xbf7fbf35, 0x3e95bf0e, 0x3f623f6d, 0xbf223e48
.long 0xbf0ebf80, 0x3f7b3ec4, 0xbe483f35, 0xbf55bf6d, 0x3e95bf35, 0x3f223f7b, 0xbf7fbec4, 0x3ef1bf0e
.long 0x3f6d8000, 0xbec43f35, 0xbec4bf80, 0x3f6d3f35, 0x3f623f35, 0xbf7fbe48, 0x3f46bec4, 0xbe953f55
.long 0x3e483f80, 0xbf0ebf6d, 0x3f553f35, 0xbf7bbec4, 0xbf223f35, 0x3ef1bf55, 0xbe953f6d, 0x3dc9bf7b
.long 0xbf803f80, 0xbf803f80, 0xbf803f80, 0xbf803f80, 0xbf7fbf80, 0xbf75bf7b, 0xbf62bf6d, 0xbf46bf55
.long 0x3e488000, 0x3f0e3ec4, 0x3f553f35, 0x3f7b3f6d, 0x3f753f80, 0x3f223f55, 0x3dc93ec4, 0xbef1be48
.long 0xbec48000, 0xbf6dbf35, 0xbf6dbf80, 0xbec4bf35, 0xbf62bf80, 0xbdc9bf0e, 0x3f463ec4, 0x3f753f7b
.long 0x3f0e8000, 0x3f7b3f6d, 0x3e483f35, 0xbf55bec4, 0x3f463f80, 0xbef13e48, 0xbf75bf6d, 0x3dc9bf0e
.long 0xbf358000, 0xbf35bf80, 0x3f358000, 0x3f353f80, 0xbf22bf80, 0x3f623e48, 0x3e953f6d, 0xbf7fbf0e
.long 0x3f558000, 0x3e483f6d, 0xbf7bbf35, 0x3f0ebec4, 0x3ef13f80, 0xbf7fbf0e, 0x3f22bec4, 0x3e953f7b
.long 0xbf6d8000, 0x3ec4bf35, 0x3ec43f80, 0xbf6dbf35, 0xbe95bf80, 0x3f463f55, 0xbf7fbec4, 0x3f62be48
.long 0x3f7b8000, 0xbf553ec4, 0x3f0ebf35, 0xbe483f6d, 0x3dc93f80, 0xbe95bf7b, 0x3ef13f6d, 0xbf22bf55
.long 0xbf803f80, 0xbf803f80, 0xbf803f80, 0xbf803f80, 0xbf22bf35, 0xbef1bf0e, 0xbe95bec4, 0xbdc9be48
.long 0x3f7b3f80, 0x3f553f6d, 0x3f0e3f35, 0x3e483ec4, 0xbf62bf35, 0xbf7fbf7b, 0xbf46bf6d, 0xbe95bf0e
.long 0x3ec48000, 0x3f6d3f35, 0x3f6d3f80, 0x3ec43f35, 0x3e953f35, 0xbf22be48, 0xbf7fbf6d, 0xbef1bf55
.long 0xbf55bf80, 0x3e48bec4, 0x3f7b3f35, 0x3f0e3f6d, 0x3f7f3f35, 0x3e953f55, 0xbf62bec4, 0xbf22bf7b
.long 0xbf358000, 0xbf35bf80, 0x3f358000, 0x3f353f80, 0x3dc9bf35, 0x3f753f55, 0xbef13ec4, 0xbf46bf7b
.long 0x3f0e3f80, 0xbf7bbec4, 0x3e48bf35, 0x3f553f6d, 0xbf75bf35, 0x3f46be48, 0x3dc93f6d, 0xbf62bf55
.long 0x3f6d8000, 0xbec43f35, 0xbec4bf80, 0x3f6d3f35, 0xbef13f35, 0xbdc9bf7b, 0x3f223f6d, 0xbf75bf0e
.long 0xbe48bf80, 0x3f0e3f6d, 0xbf55bf35, 0x3f7b3ec4, 0x3f463f35, 0xbf62bf0e, 0x3f753ec4, 0xbf7fbe48
.long 0xbf803f80, 0xbf803f80, 0xbf803f80, 0xbf803f80, 0x3dc98000, 0x3e953e48, 0x3ef13ec4, 0x3f223f0e
.long 0xbe488000, 0xbf0ebec4, 0xbf55bf35, 0xbf7bbf6d, 0x3e958000, 0x3f463f0e, 0x3f7f3f6d, 0x3f623f7b
.long 0xbec48000, 0xbf6dbf35, 0xbf6dbf80, 0xbec4bf35, 0x3ef18000, 0x3f7f3f55, 0x3f223f6d, 0xbe953e48
.long 0xbf0e8000, 0xbf7bbf6d, 0xbe48bf35, 0x3f553ec4, 0x3f228000, 0x3f623f7b, 0xbe953ec4, 0xbf7fbf55
.long 0xbf358000, 0xbf35bf80, 0x3f358000, 0x3f353f80, 0x3f468000, 0x3ef13f7b, 0xbf75bec4, 0xbdc9bf55
.long 0xbf558000, 0xbe48bf6d, 0x3f7b3f35, 0xbf0e3ec4, 0x3f628000, 0xbdc93f55, 0xbf46bf6d, 0x3f753e48
.long 0xbf6d8000, 0x3ec4bf35, 0x3ec43f80, 0xbf6dbf35, 0x3f758000, 0xbf223f0e, 0x3dc9bf6d, 0x3ef13f7b
.long 0xbf7b8000, 0x3f55bec4, 0xbf0e3f35, 0x3e48bf6d, 0x3f7f8000, 0xbf753e48, 0x3f62bec4, 0xbf463f0e
.long 0xbf803f80, 0xbf803f80, 0xbf803f80, 0xbf803f80, 0x3f463f35, 0x3f623f55, 0x3f753f6d, 0x3f7f3f7b
.long 0xbf7bbf80, 0xbf55bf6d, 0xbf0ebf35, 0xbe48bec4, 0x3ef13f35, 0xbdc93e48, 0xbf22bec4, 0xbf75bf55
.long 0x3ec48000, 0x3f6d3f35, 0x3f6d3f80, 0x3ec43f35, 0xbf75bf35, 0xbf46bf7b, 0x3dc9bec4, 0x3f623f0e
.long 0x3f553f80, 0xbe483ec4, 0xbf7bbf35, 0xbf0ebf6d, 0xbdc9bf35, 0x3f753f0e, 0x3ef13f6d, 0xbf46be48
.long 0xbf358000, 0xbf35bf80, 0x3f358000, 0x3f353f80, 0x3f7f3f35, 0xbe953f0e, 0xbf62bf6d, 0x3f22be48
.long 0xbf0ebf80, 0x3f7b3ec4, 0xbe483f35, 0xbf55bf6d, 0xbe953f35, 0xbf22bf7b, 0x3f7f3ec4, 0xbef13f0e
.long 0x3f6d8000, 0xbec43f35, 0xbec4bf80, 0x3f6d3f35, 0xbf62bf35, 0x3f7f3e48, 0xbf463ec4, 0x3e95bf55
.long 0x3e483f80, 0xbf0ebf6d, 0x3f553f35, 0xbf7bbec4, 0x3f22bf35, 0xbef13f55, 0x3e95bf6d, 0xbdc93f7b
.long 0xbf803f80, 0xbf803f80, 0xbf803f80, 0xbf803f80, 0x3f7f3f80, 0x3f753f7b, 0x3f623f6d, 0x3f463f55
.long 0x3e488000, 0x3f0e3ec4, 0x3f553f35, 0x3f7b3f6d, 0xbf75bf80, 0xbf22bf55, 0xbdc9bec4, 0x3ef13e48
.long 0xbec48000, 0xbf6dbf35, 0xbf6dbf80, 0xbec4bf35, 0x3f623f80, 0x3dc93f0e, 0xbf46bec4, 0xbf75bf7b
.long 0x3f0e8000, 0x3f7b3f6d, 0x3e483f35, 0xbf55bec4, 0xbf46bf80, 0x3ef1be48, 0x3f753f6d, 0xbdc93f0e
.long 0xbf358000, 0xbf35bf80, 0x3f358000, 0x3f353f80, 0x3f223f80, 0xbf62be48, 0xbe95bf6d, 0x3f7f3f0e
.long 0x3f558000, 0x3e483f6d, 0xbf7bbf35, 0x3f0ebec4, 0xbef1bf80, 0x3f7f3f0e, 0xbf223ec4, 0xbe95bf7b
.long 0xbf6d8000, 0x3ec4bf35, 0x3ec43f80, 0xbf6dbf35, 0x3e953f80, 0xbf46bf55, 0x3f7f3ec4, 0xbf623e48
.long 0x3f7b8000, 0xbf553ec4, 0x3f0ebf35, 0xbe483f6d, 0xbdc9bf80, 0x3e953f7b, 0xbef1bf6d, 0x3f223f55
.long 0xbf803f80, 0xbf803f80, 0xbf803f80, 0xbf803f80, 0x3f223f35, 0x3ef13f0e, 0x3e953ec4, 0x3dc93e48
.long 0x3f7b3f80, 0x3f553f6d, 0x3f0e3f35, 0x3e483ec4, 0x3f623f35, 0x3f7f3f7b, 0x3f463f6d, 0x3e953f0e
.long 0x3ec48000, 0x3f6d3f35, 0x3f6d3f80, 0x3ec43f35, 0xbe95bf35, 0x3f223e48, 0x3f7f3f6d, 0x3ef13f55
.long 0xbf55bf80, 0x3e48bec4, 0x3f7b3f35, 0x3f0e3f6d, 0xbf7fbf35, 0xbe95bf55, 0x3f623ec4, 0x3f223f7b
.long 0xbf358000, 0xbf35bf80, 0x3f358000, 0x3f353f80, 0xbdc93f35, 0xbf75bf55, 0x3ef1bec4, 0x3f463f7b
.long 0x3f0e3f80, 0xbf7bbec4, 0x3e48bf35, 0x3f553f6d, 0x3f753f35, 0xbf463e48, 0xbdc9bf6d, 0x3f623f55
.long 0x3f6d8000, 0xbec43f35, 0xbec4bf80, 0x3f6d3f35, 0x3ef1bf35, 0x3dc93f7b, 0xbf22bf6d, 0x3f753f0e
.long 0xbe48bf80, 0x3f0e3f6d, 0xbf55bf35, 0x3f7b3ec4, 0xbf46bf35, 0x3f623f0e, 0xbf75bec4, 0x3f7f3e48
.long 0xbf808000, 0x3f808000, 0xbf808000, 0x3f808000, 0xbf7f8000, 0x3f753e48, 0xbf62bec4, 0x3f463f0e
.long 0xbf7b8000, 0x3f553ec4, 0xbf0ebf35, 0x3e483f6d, 0xbf758000, 0x3f223f0e, 0xbdc9bf6d, 0xbef13f7b
.long 0xbf6d8000, 0x3ec43f35, 0x3ec4bf80, 0xbf6d3f35, 0xbf628000, 0x3dc93f55, 0x3f46bf6d, 0xbf753e48
.long 0xbf558000, 0xbe483f6d, 0x3f7bbf35, 0xbf0ebec4, 0xbf468000, 0xbef13f7b, 0x3f75bec4, 0x3dc9bf55
.long 0xbf358000, 0xbf353f80, 0x3f358000, 0x3f35bf80, 0xbf228000, 0xbf623f7b, 0x3e953ec4, 0x3f7fbf55
.long 0xbf0e8000, 0xbf7b3f6d, 0xbe483f35, 0x3f55bec4, 0xbef18000, 0xbf7f3f55, 0xbf223f6d, 0x3e953e48
.long 0xbec48000, 0xbf6d3f35, 0xbf6d3f80, 0xbec43f35, 0xbe958000, 0xbf463f0e, 0xbf7f3f6d, 0xbf623f7b
.long 0xbe488000, 0xbf0e3ec4, 0xbf553f35, 0xbf7b3f6d, 0xbdc98000, 0xbe953e48, 0xbef13ec4, 0xbf223f0e
.long 0xbf808000, 0x3f808000, 0xbf808000, 0x3f808000, 0xbf22bf35, 0x3ef13f55, 0xbe95bf6d, 0x3dc93f7b
.long 0x3e48bf80, 0xbf0e3f6d, 0x3f55bf35, 0xbf7b3ec4, 0x3f62bf35, 0xbf7f3e48, 0x3f463ec4, 0xbe95bf55
.long 0x3f6d8000, 0xbec4bf35, 0xbec43f80, 0x3f6dbf35, 0x3e953f35, 0x3f22bf7b, 0xbf7f3ec4, 0x3ef13f0e
.long 0xbf0e3f80, 0x3f7bbec4, 0xbe48bf35, 0xbf553f6d, 0xbf7f3f35, 0x3e953f0e, 0x3f62bf6d, 0xbf22be48
.long 0xbf358000, 0xbf353f80, 0x3f358000, 0x3f35bf80, 0x3dc9bf35, 0xbf753f0e, 0xbef13f6d, 0x3f46be48
.long 0x3f55bf80, 0xbe48bec4, 0xbf7b3f35, 0xbf0e3f6d, 0x3f75bf35, 0x3f46bf7b, 0xbdc9bec4, 0xbf623f0e
.long 0x3ec48000, 0x3f6dbf35, 0x3f6dbf80, 0x3ec4bf35, 0xbef13f35, 0x3dc93e48, 0x3f22bec4, 0x3f75bf55
.long 0xbf7b3f80, 0xbf553f6d, 0xbf0e3f35, 0xbe483ec4, 0xbf463f35, 0xbf623f55, 0xbf753f6d, 0xbf7f3f7b
.long 0xbf808000, 0x3f808000, 0xbf808000, 0x3f808000, 0x3dc9bf80, 0xbe953f7b, 0x3ef1bf6d, 0xbf223f55
.long 0x3f7b8000, 0xbf55bec4, 0x3f0e3f35, 0xbe48bf6d, 0xbe953f80, 0x3f46bf55, 0xbf7f3ec4, 0x3f623e48
.long 0xbf6d8000, 0x3ec43f35, 0x3ec4bf80, 0xbf6d3f35, 0x3ef1bf80, 0xbf7f3f0e, 0x3f223ec4, 0x3e95bf7b
.long 0x3f558000, 0x3e48bf6d, 0xbf7b3f35, 0x3f0e3ec4, 0xbf223f80, 0x3f62be48, 0x3e95bf6d, 0xbf7f3f0e
.long 0xbf358000, 0xbf353f80, 0x3f358000, 0x3f35bf80, 0x3f46bf80, 0xbef1be48, 0xbf753f6d, 0x3dc93f0e
.long 0x3f0e8000, 0x3f7bbf6d, 0x3e48bf35, 0xbf553ec4, 0xbf623f80, 0xbdc93f0e, 0x3f46bec4, 0x3f75bf7b
.long 0xbec48000, 0xbf6d3f35, 0xbf6d3f80, 0xbec43f35, 0x3f75bf80, 0x3f22bf55, 0x3dc9bec4, 0xbef13e48
.long 0x3e488000, 0x3f0ebec4, 0x3f55bf35, 0x3f7bbf6d, 0xbf7f3f80, 0xbf753f7b, 0xbf623f6d, 0xbf463f55
.long 0xbf808000, 0x3f808000, 0xbf808000, 0x3f808000, 0x3f46bf35, 0xbf623f0e, 0x3f75bec4, 0xbf7f3e48
.long 0xbe483f80, 0x3f0ebf6d, 0xbf553f35, 0x3f7bbec4, 0xbef1bf35, 0xbdc93f7b, 0x3f22bf6d, 0xbf753f0e
.long 0x3f6d8000, 0xbec4bf35, 0xbec43f80, 0x3f6dbf35, 0xbf753f35, 0x3f463e48, 0x3dc9bf6d, 0xbf623f55
.long 0x3f0ebf80, 0xbf7b3ec4, 0x3e483f35, 0x3f55bf6d, 0x3dc93f35, 0x3f75bf55, 0xbef1bec4, 0xbf463f7b
.long 0xbf358000, 0xbf353f80, 0x3f358000, 0x3f35bf80, 0x3f7fbf35, 0x3e95bf55, 0xbf623ec4, 0xbf223f7b
.long 0xbf553f80, 0x3e483ec4, 0x3f7bbf35, 0x3f0ebf6d, 0x3e95bf35, 0xbf223e48, 0xbf7f3f6d, 0xbef13f55
.long 0x3ec48000, 0x3f6dbf35, 0x3f6dbf80, 0x3ec4bf35, 0xbf623f35, 0xbf7f3f7b, 0xbf463f6d, 0xbe953f0e
.long 0x3f7bbf80, 0x3f55bf6d, 0x3f0ebf35, 0x3e48bec4, 0xbf223f35, 0xbef13f0e, 0xbe953ec4, 0xbdc93e48
.long 0xbf808000, 0x3f808000, 0xbf808000, 0x3f808000, 0x3f7f8000, 0xbf75be48, 0x3f623ec4, 0xbf46bf0e
.long 0xbf7b8000, 0x3f553ec4, 0xbf0ebf35, 0x3e483f6d, 0x3f758000, 0xbf22bf0e, 0x3dc93f6d, 0x3ef1bf7b
.long 0xbf6d8000, 0x3ec43f35, 0x3ec4bf80, 0xbf6d3f35, 0x3f628000, 0xbdc9bf55, 0xbf463f6d, 0x3f75be48
.long 0xbf558000, 0xbe483f6d, 0x3f7bbf35, 0xbf0ebec4, 0x3f468000, 0x3ef1bf7b, 0xbf753ec4, 0xbdc93f55
.long 0xbf358000, 0xbf353f80, 0x3f358000, 0x3f35bf80, 0x3f228000, 0x3f62bf7b, 0xbe95bec4, 0xbf7f3f55
.long 0xbf0e8000, 0xbf7b3f6d, 0xbe483f35, 0x3f55bec4, 0x3ef18000, 0x3f7fbf55, 0x3f22bf6d, 0xbe95be48
.long 0xbec48000, 0xbf6d3f35, 0xbf6d3f80, 0xbec43f35, 0x3e958000, 0x3f46bf0e, 0x3f7fbf6d, 0x3f62bf7b
.long 0xbe488000, 0xbf0e3ec4, 0xbf553f35, 0xbf7b3f6d, 0x3dc98000, 0x3e95be48, 0x3ef1bec4, 0x3f22bf0e
.long 0xbf808000, 0x3f808000, 0xbf808000, 0x3f808000, 0x3f223f35, 0xbef1bf55, 0x3e953f6d, 0xbdc9bf7b
.long 0x3e48bf80, 0xbf0e3f6d, 0x3f55bf35, 0xbf7b3ec4, 0xbf623f35, 0x3f7fbe48, 0xbf46bec4, 0x3e953f55
.long 0x3f6d8000, 0xbec4bf35, 0xbec43f80, 0x3f6dbf35, 0xbe95bf35, 0xbf223f7b, 0x3f7fbec4, 0xbef1bf0e
.long 0xbf0e3f80, 0x3f7bbec4, 0xbe48bf35, 0xbf553f6d, 0x3f7fbf35, 0xbe95bf0e, 0xbf623f6d, 0x3f223e48
.long 0xbf358000, 0xbf353f80, 0x3f358000, 0x3f35bf80, 0xbdc93f35, 0x3f75bf0e, 0x3ef1bf6d, 0xbf463e48
.long 0x3f55bf80, 0xbe48bec4, 0xbf7b3f35, 0xbf0e3f6d, 0xbf753f35, 0xbf463f7b, 0x3dc93ec4, 0x3f62bf0e
.long 0x3ec48000, 0x3f6dbf35, 0x3f6dbf80, 0x3ec4bf35, 0x3ef1bf35, 0xbdc9be48, 0xbf223ec4, 0xbf753f55
.long 0xbf7b3f80, 0xbf553f6d, 0xbf0e3f35, 0xbe483ec4, 0x3f46bf35, 0x3f62bf55, 0x3f75bf6d, 0x3f7fbf7b
.long 0xbf808000, 0x3f808000, 0xbf808000, 0x3f808000, 0xbdc93f80, 0x3e95bf7b, 0xbef13f6d, 0x3f22bf55
.long 0x3f7b8000, 0xbf55bec4, 0x3f0e3f35, 0xbe48bf6d, 0x3e95bf80, 0xbf463f55, 0x3f7fbec4, 0xbf62be48
.long 0xbf6d8000, 0x3ec43f35, 0x3ec4bf80, 0xbf6d3f35, 0xbef13f80, 0x3f7fbf0e, 0xbf22bec4, 0xbe953f7b
.long 0x3f558000, 0x3e48bf6d, 0xbf7b3f35, 0x3f0e3ec4, 0x3f22bf80, 0xbf623e48, 0xbe953f6d, 0x3f7fbf0e
.long 0xbf358000, 0xbf353f80, 0x3f358000, 0x3f35bf80, 0xbf463f80, 0x3ef13e48, 0x3f75bf6d, 0xbdc9bf0e
.long 0x3f0e8000, 0x3f7bbf6d, 0x3e48bf35, 0xbf553ec4, 0x3f62bf80, 0x3dc9bf0e, 0xbf463ec4, 0xbf753f7b
.long 0xbec48000, 0xbf6d3f35, 0xbf6d3f80, 0xbec43f35, 0xbf753f80, 0xbf223f55, 0xbdc93ec4, 0x3ef1be48
.long 0x3e488000, 0x3f0ebec4, 0x3f55bf35, 0x3f7bbf6d, 0x3f7fbf80, 0x3f75bf7b, 0x3f62bf6d, 0x3f46bf55
.long 0xbf808000, 0x3f808000, 0xbf808000, 0x3f808000, 0xbf463f35, 0x3f62bf0e, 0xbf753ec4, 0x3f7fbe48
.long 0xbe483f80, 0x3f0ebf6d, 0xbf553f35, 0x3f7bbec4, 0x3ef13f35, 0x3dc9bf7b, 0xbf223f6d, 0x3f75bf0e
.long 0x3f6d8000, 0xbec4bf35, 0xbec43f80, 0x3f6dbf35, 0x3f75bf35, 0xbf46be48, 0xbdc93f6d, 0x3f62bf55
.long 0x3f0ebf80, 0xbf7b3ec4, 0x3e483f35, 0x3f55bf6d, 0xbdc9bf35, 0xbf753f55, 0x3ef13ec4, 0x3f46bf7b
.long 0xbf358000, 0xbf353f80, 0x3f358000, 0x3f35bf80, 0xbf7f3f35, 0xbe953f55, 0x3f62bec4, 0x3f22bf7b
.long 0xbf553f80, 0x3e483ec4, 0x3f7bbf35, 0x3f0ebf6d, 0xbe953f35, 0x3f22be48, 0x3f7fbf6d, 0x3ef1bf55
.long 0x3ec48000, 0x3f6dbf35, 0x3f6dbf80, 0x3ec4bf35, 0x3f62bf35, 0x3f7fbf7b, 0x3f46bf6d, 0x3e95bf0e
.long 0x3f7bbf80, 0x3f55bf6d, 0x3f0ebf35, 0x3e48bec4, 0x3f22bf35, 0x3ef1bf0e, 0x3e95bec4, 0x3dc9be48
.long 0x00003f80, 0x00003f80, 0x00003f80, 0x00003f80, 0x3f808000, 0x3f808000, 0x3f808000, 0x3f808000
.long 0x00003f80, 0x3ec43f6d, 0x3f353f35, 0x3f6d3ec4, 0x3f808000, 0x3f6dbec4, 0x3f35bf35, 0x3ec4bf6d
.long 0x00003f80, 0x3f353f35, 0x3f800000, 0x3f35bf35, 0x3f808000, 0x3f35bf35, 0x0000bf80, 0xbf35bf35
.long 0x00003f80, 0x3f6d3ec4, 0x3f35bf35, 0xbec4bf6d, 0x3f808000, 0x3ec4bf6d, 0xbf35bf35, 0xbf6d3ec4
.long 0x00003f80, 0x3f800000, 0x0000bf80, 0xbf800000, 0x3f808000, 0x0000bf80, 0xbf808000, 0x00003f80
.long 0x00003f80, 0x3f6dbec4, 0xbf35bf35, 0xbec43f6d, 0x3f808000, 0xbec4bf6d, 0xbf353f35, 0x3f6d3ec4
.long 0x00003f80, 0x3f35bf35, 0xbf800000, 0x3f353f35, 0x3f808000, 0xbf35bf35, 0x00003f80, 0x3f35bf35
.long 0x00003f80, 0x3ec4bf6d, 0xbf353f35, 0x3f6dbec4, 0x3f808000, 0xbf6dbec4, 0x3f353f35, 0xbec4bf6d
.long 0x00003f80, 0x00003f80, 0x00003f80, 0x00003f80, 0x3f808000, 0x3f808000, 0x3f808000, 0x3f808000
.long 0x3f800000, 0x3f6dbec4, 0x3f35bf35, 0x3ec4bf6d, 0x0000bf80, 0xbec4bf6d, 0xbf35bf35, 0xbf6dbec4
.long 0x0000bf80, 0xbf35bf35, 0xbf800000, 0xbf353f35, 0xbf808000, 0xbf353f35, 0x00003f80, 0x3f353f35
.long 0xbf800000, 0xbec43f6d, 0x3f353f35, 0x3f6dbec4, 0x00003f80, 0x3f6d3ec4, 0x3f35bf35, 0xbec4bf6d
.long 0x00003f80, 0x3f800000, 0x0000bf80, 0xbf800000, 0x3f808000, 0x0000bf80, 0xbf808000, 0x00003f80
.long 0x3f800000, 0xbec4bf6d, 0xbf353f35, 0x3f6d3ec4, 0x0000bf80, 0xbf6d3ec4, 0x3f353f35, 0x3ec4bf6d
.long 0x0000bf80, 0xbf353f35, 0x3f800000, 0xbf35bf35, 0xbf808000, 0x3f353f35, 0x0000bf80, 0xbf353f35
.long 0xbf800000, 0x3f6d3ec4, 0xbf35bf35, 0x3ec43f6d, 0x00003f80, 0x3ec4bf6d, 0xbf353f35, 0x3f6dbec4
.long 0x00003f80, 0x00003f80, 0x00003f80, 0x00003f80, 0x3f808000, 0x3f808000, 0x3f808000, 0x3f808000
.long 0x0000bf80, 0xbec4bf6d, 0xbf35bf35, 0xbf6dbec4, 0xbf808000, 0xbf6d3ec4, 0xbf353f35, 0xbec43f6d
.long 0x00003f80, 0x3f353f35, 0x3f800000, 0x3f35bf35, 0x3f808000, 0x3f35bf35, 0x0000bf80, 0xbf35bf35
.long 0x0000bf80, 0xbf6dbec4, 0xbf353f35, 0x3ec43f6d, 0xbf808000, 0xbec43f6d, 0x3f353f35, 0x3f6dbec4
.long 0x00003f80, 0x3f800000, 0x0000bf80, 0xbf800000, 0x3f808000, 0x0000bf80, 0xbf808000, 0x00003f80
.long 0x0000bf80, 0xbf6d3ec4, 0x3f353f35, 0x3ec4bf6d, 0xbf808000, 0x3ec43f6d, 0x3f35bf35, 0xbf6dbec4
.long 0x00003f80, 0x3f35bf35, 0xbf800000, 0x3f353f35, 0x3f808000, 0xbf35bf35, 0x00003f80, 0x3f35bf35
.long 0x0000bf80, 0xbec43f6d, 0x3f35bf35, 0xbf6d3ec4, 0xbf808000, 0x3f6d3ec4, 0xbf35bf35, 0x3ec43f6d
.long 0x00003f80, 0x00003f80, 0x00003f80, 0x00003f80, 0x3f808000, 0x3f808000, 0x3f808000, 0x3f808000
.long 0xbf800000, 0xbf6d3ec4, 0xbf353f35, 0xbec43f6d, 0x00003f80, 0x3ec43f6d, 0x3f353f35, 0x3f6d3ec4
.long 0x0000bf80, 0xbf35bf35, 0xbf800000, 0xbf353f35, 0xbf808000, 0xbf353f35, 0x00003f80, 0x3f353f35
.long 0x3f800000, 0x3ec4bf6d, 0xbf35bf35, 0xbf6d3ec4, 0x0000bf80, 0xbf6dbec4, 0xbf353f35, 0x3ec43f6d
.long 0x00003f80, 0x3f800000, 0x0000bf80, 0xbf800000, 0x3f808000, 0x0000bf80, 0xbf808000, 0x00003f80
.long 0xbf800000, 0x3ec43f6d, 0x3f35bf35, 0xbf6dbec4, 0x00003f80, 0x3f6dbec4, 0xbf35bf35, 0xbec43f6d
.long 0x0000bf80, 0xbf353f35, 0x3f800000, 0xbf35bf35, 0xbf808000, 0x3f353f35, 0x0000bf80, 0xbf353f35
.long 0x3f800000, 0xbf6dbec4, 0x3f353f35, 0xbec4bf6d, 0x0000bf80, 0xbec43f6d, 0x3f35bf35, 0xbf6d3ec4
.long 0x00003f80, 0x0000bf80, 0x00003f80, 0x0000bf80, 0x3f808000, 0xbf808000, 0x3f808000, 0xbf808000
.long 0x00003f80, 0xbec4bf6d, 0x3f353f35, 0xbf6dbec4, 0x3f808000, 0xbf6d3ec4, 0x3f35bf35, 0xbec43f6d
.long 0x00003f80, 0xbf35bf35, 0x3f800000, 0xbf353f35, 0x3f808000, 0xbf353f35, 0x0000bf80, 0x3f353f35
.long 0x00003f80, 0xbf6dbec4, 0x3f35bf35, 0x3ec43f6d, 0x3f808000, 0xbec43f6d, 0xbf35bf35, 0x3f6dbec4
.long 0x00003f80, 0xbf800000, 0x0000bf80, 0x3f800000, 0x3f808000, 0x00003f80, 0xbf808000, 0x0000bf80
.long 0x00003f80, 0xbf6d3ec4, 0xbf35bf35, 0x3ec4bf6d, 0x3f808000, 0x3ec43f6d, 0xbf353f35, 0xbf6dbec4
.long 0x00003f80, 0xbf353f35, 0xbf800000, 0xbf35bf35, 0x3f808000, 0x3f353f35, 0x00003f80, 0xbf353f35
.long 0x00003f80, 0xbec43f6d, 0xbf353f35, 0xbf6d3ec4, 0x3f808000, 0x3f6d3ec4, 0x3f353f35, 0x3ec43f6d
.long 0x00003f80, 0x0000bf80, 0x00003f80, 0x0000bf80, 0x3f808000, 0xbf808000, 0x3f808000, 0xbf808000
.long 0x3f800000, 0xbf6d3ec4, 0x3f35bf35, 0xbec43f6d, 0x0000bf80, 0x3ec43f6d, 0xbf35bf35, 0x3f6d3ec4
.long 0x0000bf80, 0x3f353f35, 0xbf800000, 0x3f35bf35, 0xbf808000, 0x3f35bf35, 0x00003f80, 0xbf35bf35
.long 0xbf800000, 0x3ec4bf6d, 0x3f353f35, 0xbf6d3ec4, 0x00003f80, 0xbf6dbec4, 0x3f35bf35, 0x3ec43f6d
.long 0x00003f80, 0xbf800000, 0x0000bf80, 0x3f800000, 0x3f808000, 0x00003f80, 0xbf808000, 0x0000bf80
.long 0x3f800000, 0x3ec43f6d, 0xbf353f35, 0xbf6dbec4, 0x0000bf80, 0x3f6dbec4, 0x3f353f35, 0xbec43f6d
.long 0x0000bf80, 0x3f35bf35, 0x3f800000, 0x3f353f35, 0xbf808000, 0xbf35bf35, 0x0000bf80, 0x3f35bf35
.long 0xbf800000, 0xbf6dbec4, 0xbf35bf35, 0xbec4bf6d, 0x00003f80, 0xbec43f6d, 0xbf353f35, 0xbf6d3ec4
.long 0x00003f80, 0x0000bf80, 0x00003f80, 0x0000bf80, 0x3f808000, 0xbf808000, 0x3f808000, 0xbf808000
.long 0x0000bf80, 0x3ec43f6d, 0xbf35bf35, 0x3f6d3ec4, 0xbf808000, 0x3f6dbec4, 0xbf353f35, 0x3ec4bf6d
.long 0x00003f80, 0xbf35bf35, 0x3f800000, 0xbf353f35, 0x3f808000, 0xbf353f35, 0x0000bf80, 0x3f353f35
.long 0x0000bf80, 0x3f6d3ec4, 0xbf353f35, 0xbec4bf6d, 0xbf808000, 0x3ec4bf6d, 0x3f353f35, 0xbf6d3ec4
.long 0x00003f80, 0xbf800000, 0x0000bf80, 0x3f800000, 0x3f808000, 0x00003f80, 0xbf808000, 0x0000bf80
.long 0x0000bf80, 0x3f6dbec4, 0x3f353f35, 0xbec43f6d, 0xbf808000, 0xbec4bf6d, 0x3f35bf35, 0x3f6d3ec4
.long 0x00003f80, 0xbf353f35, 0xbf800000, 0xbf35bf35, 0x3f808000, 0x3f353f35, 0x00003f80, 0xbf353f35
.long 0x0000bf80, 0x3ec4bf6d, 0x3f35bf35, 0x3f6dbec4, 0xbf808000, 0xbf6dbec4, 0xbf35bf35, 0xbec4bf6d
.long 0x00003f80, 0x0000bf80, 0x00003f80, 0x0000bf80, 0x3f808000, 0xbf808000, 0x3f808000, 0xbf808000
.long 0xbf800000, 0x3f6dbec4, 0xbf353f35, 0x3ec4bf6d, 0x00003f80, 0xbec4bf6d, 0x3f353f35, 0xbf6dbec4
.long 0x0000bf80, 0x3f353f35, 0xbf800000, 0x3f35bf35, 0xbf808000, 0x3f35bf35, 0x00003f80, 0xbf35bf35
.long 0x3f800000, 0xbec43f6d, 0xbf35bf35, 0x3f6dbec4, 0x0000bf80, 0x3f6d3ec4, 0xbf353f35, 0xbec4bf6d
.long 0x00003f80, 0xbf800000, 0x0000bf80, 0x3f800000, 0x3f808000, 0x00003f80, 0xbf808000, 0x0000bf80
.long 0xbf800000, 0xbec4bf6d, 0x3f35bf35, 0x3f6d3ec4, 0x00003f80, 0xbf6d3ec4, 0xbf35bf35, 0x3ec4bf6d
.long 0x0000bf80, 0x3f35bf35, 0x3f800000, 0x3f353f35, 0xbf808000, 0xbf35bf35, 0x0000bf80, 0x3f35bf35
.long 0x3f800000, 0x3f6d3ec4, 0x3f353f35, 0x3ec43f6d, 0x0000bf80, 0x3ec4bf6d, 0x3f35bf35, 0x3f6dbec4
.long 0x00003f80, 0x00003f80, 0x00003f80, 0x00003f80, 0x00003f80, 0x3e483f7b, 0x3ec43f6d, 0x3f0e3f55
.long 0x00003f80, 0x3ec43f6d, 0x3f353f35, 0x3f6d3ec4, 0x00003f80, 0x3f0e3f55, 0x3f6d3ec4, 0x3f7bbe48
.long 0x00003f80, 0x3f353f35, 0x3f800000, 0x3f35bf35, 0x00003f80, 0x3f553f0e, 0x3f6dbec4, 0x3e48bf7b
.long 0x00003f80, 0x3f6d3ec4, 0x3f35bf35, 0xbec4bf6d, 0x00003f80, 0x3f7b3e48, 0x3ec4bf6d, 0xbf55bf0e
.long 0x00003f80, 0x3f800000, 0x0000bf80, 0xbf800000, 0x00003f80, 0x3f7bbe48, 0xbec4bf6d, 0xbf553f0e
.long 0x00003f80, 0x3f6dbec4, 0xbf35bf35, 0xbec43f6d, 0x00003f80, 0x3f55bf0e, 0xbf6dbec4, 0x3e483f7b
.long 0x00003f80, 0x3f35bf35, 0xbf800000, 0x3f353f35, 0x00003f80, 0x3f0ebf55, 0xbf6d3ec4, 0x3f7b3e48
.long 0x00003f80, 0x3ec4bf6d, 0xbf353f35, 0x3f6dbec4, 0x00003f80, 0x3e48bf7b, 0xbec43f6d, 0x3f0ebf55
.long 0x00003f80, 0x00003f80, 0x00003f80, 0x00003f80, 0x3f353f35, 0x3f553f0e, 0x3f6d3ec4, 0x3f7b3e48
.long 0x3f800000, 0x3f6dbec4, 0x3f35bf35, 0x3ec4bf6d, 0x3f35bf35, 0x3e48bf7b, 0xbec4bf6d, 0xbf55bf0e
.long 0x0000bf80, 0xbf35bf35, 0xbf800000, 0xbf353f35, 0xbf35bf35, 0xbf7b3e48, 0xbec43f6d, 0x3f0e3f55
.long 0xbf800000, 0xbec43f6d, 0x3f353f35, 0x3f6dbec4, 0xbf353f35, 0x3f0e3f55, 0x3f6dbec4, 0xbe48bf7b
.long 0x00003f80, 0x3f800000, 0x0000bf80, 0xbf800000, 0x3f353f35, 0x3f0ebf55, 0xbf6dbec4, 0xbe483f7b
.long 0x3f800000, 0xbec4bf6d, 0xbf353f35, 0x3f6d3ec4, 0x3f35bf35, 0xbf7bbe48, 0x3ec43f6d, 0x3f0ebf55
.long 0x0000bf80, 0xbf353f35, 0x3f800000, 0xbf35bf35, 0xbf35bf35, 0x3e483f7b, 0x3ec4bf6d, 0xbf553f0e
.long 0xbf800000, 0x3f6d3ec4, 0xbf35bf35, 0x3ec43f6d, 0xbf353f35, 0x3f55bf0e, 0xbf6d3ec4, 0x3f7bbe48
.long 0x00003f80, 0x00003f80, 0x00003f80, 0x00003f80, 0x3f800000, 0x3f7bbe48, 0x3f6dbec4, 0x3f55bf0e
.long 0x0000bf80, 0xbec4bf6d, 0xbf35bf35, 0xbf6dbec4, 0xbf800000, 0xbf553f0e, 0xbec43f6d, 0x3e483f7b
.long 0x00003f80, 0x3f353f35, 0x3f800000, 0x3f35bf35, 0x3f800000, 0x3f0ebf55, 0xbec4bf6d, 0xbf7bbe48
.long 0x0000bf80, 0xbf6dbec4, 0xbf353f35, 0x3ec43f6d, 0xbf800000, 0xbe483f7b, 0x3f6d3ec4, 0x3f0ebf55
.long 0x00003f80, 0x3f800000, 0x0000bf80, 0xbf800000, 0x3f800000, 0xbe48bf7b, 0xbf6d3ec4, 0x3f0e3f55
.long 0x0000bf80, 0xbf6d3ec4, 0x3f353f35, 0x3ec4bf6d, 0xbf800000, 0x3f0e3f55, 0x3ec4bf6d, 0xbf7b3e48
.long 0x00003f80, 0x3f35bf35, 0xbf800000, 0x3f353f35, 0x3f800000, 0xbf55bf0e, 0x3ec43f6d, 0x3e48bf7b
.long 0x0000bf80, 0xbec43f6d, 0x3f35bf35, 0xbf6d3ec4, 0xbf800000, 0x3f7b3e48, 0xbf6dbec4, 0x3f553f0e
.long 0x00003f80, 0x00003f80, 0x00003f80, 0x00003f80, 0x3f35bf35, 0x3f0ebf55, 0x3ec4bf6d, 0x3e48bf7b
.long 0xbf800000, 0xbf6d3ec4, 0xbf353f35, 0xbec43f6d, 0x3f353f35, 0x3f7b3e48, 0x3f6dbec4, 0x3f0ebf55
.long 0x0000bf80, 0xbf35bf35, 0xbf800000, 0xbf353f35, 0xbf353f35, 0x3e483f7b, 0x3f6d3ec4, 0x3f55bf0e
.long 0x3f800000, 0x3ec4bf6d, 0xbf35bf35, 0xbf6d3ec4, 0xbf35bf35, 0xbf553f0e, 0x3ec43f6d, 0x3f7bbe48
.long 0x00003f80, 0x3f800000, 0x0000bf80, 0xbf800000, 0x3f35bf35, 0xbf55bf0e, 0xbec43f6d, 0x3f7b3e48
.long 0xbf800000, 0x3ec43f6d, 0x3f35bf35, 0xbf6dbec4, 0x3f353f35, 0x3e48bf7b, 0xbf6d3ec4, 0x3f553f0e
.long 0x0000bf80, 0xbf353f35, 0x3f800000, 0xbf35bf35, 0xbf353f35, 0x3f7bbe48, 0xbf6dbec4, 0x3f0e3f55
.long 0x3f800000, 0xbf6dbec4, 0x3f353f35, 0xbec4bf6d, 0xbf35bf35, 0x3f0e3f55, 0xbec4bf6d, 0x3e483f7b
.long 0x00003f80, 0x00003f80, 0x00003f80, 0x00003f80, 0x0000bf80, 0xbe48bf7b, 0xbec4bf6d, 0xbf0ebf55
.long 0x00003f80, 0x3ec43f6d, 0x3f353f35, 0x3f6d3ec4, 0x0000bf80, 0xbf0ebf55, 0xbf6dbec4, 0xbf7b3e48
.long 0x00003f80, 0x3f353f35, 0x3f800000, 0x3f35bf35, 0x0000bf80, 0xbf55bf0e, 0xbf6d3ec4, 0xbe483f7b
.long 0x00003f80, 0x3f6d3ec4, 0x3f35bf35, 0xbec4bf6d, 0x0000bf80, 0xbf7bbe48, 0xbec43f6d, 0x3f553f0e
.long 0x00003f80, 0x3f800000, 0x0000bf80, 0xbf800000, 0x0000bf80, 0xbf7b3e48, 0x3ec43f6d, 0x3f55bf0e
.long 0x00003f80, 0x3f6dbec4, 0xbf35bf35, 0xbec43f6d, 0x0000bf80, 0xbf553f0e, 0x3f6d3ec4, 0xbe48bf7b
.long 0x00003f80, 0x3f35bf35, 0xbf800000, 0x3f353f35, 0x0000bf80, 0xbf0e3f55, 0x3f6dbec4, 0xbf7bbe48
.long 0x00003f80, 0x3ec4bf6d, 0xbf353f35, 0x3f6dbec4, 0x0000bf80, 0xbe483f7b, 0x3ec4bf6d, 0xbf0e3f55
.long 0x00003f80, 0x00003f80, 0x00003f80, 0x00003f80, 0xbf35bf35, 0xbf55bf0e, 0xbf6dbec4, 0xbf7bbe48
.long 0x3f800000, 0x3f6dbec4, 0x3f35bf35, 0x3ec4bf6d, 0xbf353f35, 0xbe483f7b, 0x3ec43f6d, 0x3f553f0e
.long 0x0000bf80, 0xbf35bf35, 0xbf800000, 0xbf353f35, 0x3f353f35, 0x3f7bbe48, 0x3ec4bf6d, 0xbf0ebf55
.long 0xbf800000, 0xbec43f6d, 0x3f353f35, 0x3f6dbec4, 0x3f35bf35, 0xbf0ebf55, 0xbf6d3ec4, 0x3e483f7b
.long 0x00003f80, 0x3f800000, 0x0000bf80, 0xbf800000, 0xbf35bf35, 0xbf0e3f55, 0x3f6d3ec4, 0x3e48bf7b
.long 0x3f800000, 0xbec4bf6d, 0xbf353f35, 0x3f6d3ec4, 0xbf353f35, 0x3f7b3e48, 0xbec4bf6d, 0xbf0e3f55
.long 0x0000bf80, 0xbf353f35, 0x3f800000, 0xbf35bf35, 0x3f353f35, 0xbe48bf7b, 0xbec43f6d, 0x3f55bf0e
.long 0xbf800000, 0x3f6d3ec4, 0xbf35bf35, 0x3ec43f6d, 0x3f35bf35, 0xbf553f0e, 0x3f6dbec4, 0xbf7b3e48
.long 0x00003f80, 0x00003f80, 0x00003f80, 0x00003f80, 0xbf800000, 0xbf7b3e48, 0xbf6d3ec4, 0xbf553f0e
.long 0x0000bf80, 0xbec4bf6d, 0xbf35bf35, 0xbf6dbec4, 0x3f800000, 0x3f55bf0e, 0x3ec4bf6d, 0xbe48bf7b
.long 0x00003f80, 0x3f353f35, 0x3f800000, 0x3f35bf35, 0xbf800000, 0xbf0e3f55, 0x3ec43f6d, 0x3f7b3e48
.long 0x0000bf80, 0xbf6dbec4, 0xbf353f35, 0x3ec43f6d, 0x3f800000, 0x3e48bf7b, 0xbf6dbec4, 0xbf0e3f55
.long 0x00003f80, 0x3f800000, 0x0000bf80, 0xbf800000, 0xbf800000, 0x3e483f7b, 0x3f6dbec4, 0xbf0ebf55
.long 0x0000bf80, 0xbf6d3ec4, 0x3f353f35, 0x3ec4bf6d, 0x3f800000, 0xbf0ebf55, 0xbec43f6d, 0x3f7bbe48
.long 0x00003f80, 0x3f35bf35, 0xbf800000, 0x3f353f35, 0xbf800000, 0x3f553f0e, 0xbec4bf6d, 0xbe483f7b
.long 0x0000bf80, 0xbec43f6d, 0x3f35bf35, 0xbf6d3ec4, 0x3f800000, 0xbf7bbe48, 0x3f6d3ec4, 0xbf55bf0e
.long 0x00003f80, 0x00003f80, 0x00003f80, 0x00003f80, 0xbf353f35, 0xbf0e3f55, 0xbec43f6d, 0xbe483f7b
.long 0xbf800000, 0xbf6d3ec4, 0xbf353f35, 0xbec43f6d, 0xbf35bf35, 0xbf7bbe48, 0xbf6d3ec4, 0xbf0e3f55
.long 0x0000bf80, 0xbf35bf35, 0xbf800000, 0xbf353f35, 0x3f35bf35, 0xbe48bf7b, 0xbf6dbec4, 0xbf553f0e
.long 0x3f800000, 0x3ec4bf6d, 0xbf35bf35, 0xbf6d3ec4, 0x3f353f35, 0x3f55bf0e, 0xbec4bf6d, 0xbf7b3e48
.long 0x00003f80, 0x3f800000, 0x0000bf80, 0xbf800000, 0xbf353f35, 0x3f553f0e, 0x3ec4bf6d, 0xbf7bbe48
.long 0xbf800000, 0x3ec43f6d, 0x3f35bf35, 0xbf6dbec4, 0xbf35bf35, 0xbe483f7b, 0x3f6dbec4, 0xbf55bf0e
.long 0x0000bf80, 0xbf353f35, 0x3f800000, 0xbf35bf35, 0x3f35bf35, 0xbf7b3e48, 0x3f6d3ec4, 0xbf0ebf55
.long 0x3f800000, 0xbf6dbec4, 0x3f353f35, 0xbec4bf6d, 0x3f353f35, 0xbf0ebf55, 0x3ec43f6d, 0xbe48bf7b
.long 0x00003f80, 0x0000bf80, 0x00003f80, 0x0000bf80, 0x00003f80, 0xbe48bf7b, 0x3ec43f6d, 0xbf0ebf55
.long 0x00003f80, 0xbec4bf6d, 0x3f353f35, 0xbf6dbec4, 0x00003f80, 0xbf0ebf55, 0x3f6d3ec4, 0xbf7b3e48
.long 0x00003f80, 0xbf35bf35, 0x3f800000, 0xbf353f35, 0x00003f80, 0xbf55bf0e, 0x3f6dbec4, 0xbe483f7b
.long 0x00003f80, 0xbf6dbec4, 0x3f35bf35, 0x3ec43f6d, 0x00003f80, 0xbf7bbe48, 0x3ec4bf6d, 0x3f553f0e
.long 0x00003f80, 0xbf800000, 0x0000bf80, 0x3f800000, 0x00003f80, 0xbf7b3e48, 0xbec4bf6d, 0x3f55bf0e
.long 0x00003f80, 0xbf6d3ec4, 0xbf35bf35, 0x3ec4bf6d, 0x00003f80, 0xbf553f0e, 0xbf6dbec4, 0xbe48bf7b
.long 0x00003f80, 0xbf353f35, 0xbf800000, 0xbf35bf35, 0x00003f80, 0xbf0e3f55, 0xbf6d3ec4, 0xbf7bbe48
.long 0x00003f80, 0xbec43f6d, 0xbf353f35, 0xbf6d3ec4, 0x00003f80, 0xbe483f7b, 0xbec43f6d, 0xbf0e3f55
.long 0x00003f80, 0x0000bf80, 0x00003f80, 0x0000bf80, 0x3f353f35, 0xbf55bf0e, 0x3f6d3ec4, 0xbf7bbe48
.long 0x3f800000, 0xbf6d3ec4, 0x3f35bf35, 0xbec43f6d, 0x3f35bf35, 0xbe483f7b, 0xbec4bf6d, 0x3f553f0e
.long 0x0000bf80, 0x3f353f35, 0xbf800000, 0x3f35bf35, 0xbf35bf35, 0x3f7bbe48, 0xbec43f6d, 0xbf0ebf55
.long 0xbf800000, 0x3ec4bf6d, 0x3f353f35, 0xbf6d3ec4, 0xbf353f35, 0xbf0ebf55, 0x3f6dbec4, 0x3e483f7b
.long 0x00003f80, 0xbf800000, 0x0000bf80, 0x3f800000, 0x3f353f35, 0xbf0e3f55, 0xbf6dbec4, 0x3e48bf7b
.long 0x3f800000, 0x3ec43f6d, 0xbf353f35, 0xbf6dbec4, 0x3f35bf35, 0x3f7b3e48, 0x3ec43f6d, 0xbf0e3f55
.long 0x0000bf80, 0x3f35bf35, 0x3f800000, 0x3f353f35, 0xbf35bf35, 0xbe48bf7b, 0x3ec4bf6d, 0x3f55bf0e
.long 0xbf800000, 0xbf6dbec4, 0xbf35bf35, 0xbec4bf6d, 0xbf353f35, 0xbf553f0e, 0xbf6d3ec4, 0xbf7b3e48
.long 0x00003f80, 0x0000bf80, 0x00003f80, 0x0000bf80, 0x3f800000, 0xbf7b3e48, 0x3f6dbec4, 0xbf553f0e
.long 0x0000bf80, 0x3ec43f6d, 0xbf35bf35, 0x3f6d3ec4, 0xbf800000, 0x3f55bf0e, 0xbec43f6d, 0xbe48bf7b
.long 0x00003f80, 0xbf35bf35, 0x3f800000, 0xbf353f35, 0x3f800000, 0xbf0e3f55, 0xbec4bf6d, 0x3f7b3e48
.long 0x0000bf80, 0x3f6d3ec4, 0xbf353f35, 0xbec4bf6d, 0xbf800000, 0x3e48bf7b, 0x3f6d3ec4, 0xbf0e3f55
.long 0x00003f80, 0xbf800000, 0x0000bf80, 0x3f800000, 0x3f800000, 0x3e483f7b, 0xbf6d3ec4, 0xbf0ebf55
.long 0x0000bf80, 0x3f6dbec4, 0x3f353f35, 0xbec43f6d, 0xbf800000, 0xbf0ebf55, 0x3ec4bf6d, 0x3f7bbe48
.long 0x00003f80, 0xbf353f35, 0xbf800000, 0xbf35bf35, 0x3f800000, 0x3f553f0e, 0x3ec43f6d, 0xbe483f7b
.long 0x0000bf80, 0x3ec4bf6d, 0x3f35bf35, 0x3f6dbec4, 0xbf800000, 0xbf7bbe48, 0xbf6dbec4, 0xbf55bf0e
.long 0x00003f80, 0x0000bf80, 0x00003f80, 0x0000bf80, 0x3f35bf35, 0xbf0e3f55, 0x3ec4bf6d, 0xbe483f7b
.long 0xbf800000, 0x3f6dbec4, 0xbf353f35, 0x3ec4bf6d, 0x3f353f35, 0xbf7bbe48, 0x3f6dbec4, 0xbf0e3f55
.long 0x0000bf80, 0x3f353f35, 0xbf800000, 0x3f35bf35, 0xbf353f35, 0xbe48bf7b, 0x3f6d3ec4, 0xbf553f0e
.long 0x3f800000, 0xbec43f6d, 0xbf35bf35, 0x3f6dbec4, 0xbf35bf35, 0x3f55bf0e, 0x3ec43f6d, 0xbf7b3e48
.long 0x00003f80, 0xbf800000, 0x0000bf80, 0x3f800000, 0x3f35bf35, 0x3f553f0e, 0xbec43f6d, 0xbf7bbe48
.long 0xbf800000, 0xbec4bf6d, 0x3f35bf35, 0x3f6d3ec4, 0x3f353f35, 0xbe483f7b, 0xbf6d3ec4, 0xbf55bf0e
.long 0x0000bf80, 0x3f35bf35, 0x3f800000, 0x3f353f35, 0xbf353f35, 0xbf7b3e48, 0xbf6dbec4, 0xbf0ebf55
.long 0x3f800000, 0x3f6d3ec4, 0x3f353f35, 0x3ec43f6d, 0xbf35bf35, 0xbf0ebf55, 0xbec4bf6d, 0xbe48bf7b
.long 0x00003f80, 0x0000bf80, 0x00003f80, 0x0000bf80, 0x0000bf80, 0x3e483f7b, 0xbec4bf6d, 0x3f0e3f55
.long 0x00003f80, 0xbec4bf6d, 0x3f353f35, 0xbf6dbec4, 0x0000bf80, 0x3f0e3f55, 0xbf6dbec4, 0x3f7bbe48
.long 0x00003f80, 0xbf35bf35, 0x3f800000, 0xbf353f35, 0x0000bf80, 0x3f553f0e, 0xbf6d3ec4, 0x3e48bf7b
.long 0x00003f80, 0xbf6dbec4, 0x3f35bf35, 0x3ec43f6d, 0x0000bf80, 0x3f7b3e48, 0xbec43f6d, 0xbf55bf0e
.long 0x00003f80, 0xbf800000, 0x0000bf80, 0x3f800000, 0x0000bf80, 0x3f7bbe48, 0x3ec43f6d, 0xbf553f0e
.long 0x00003f80, 0xbf6d3ec4, 0xbf35bf35, 0x3ec4bf6d, 0x0000bf80, 0x3f55bf0e, 0x3f6d3ec4, 0x3e483f7b
.long 0x00003f80, 0xbf353f35, 0xbf800000, 0xbf35bf35, 0x0000bf80, 0x3f0ebf55, 0x3f6dbec4, 0x3f7b3e48
.long 0x00003f80, 0xbec43f6d, 0xbf353f35, 0xbf6d3ec4, 0x0000bf80, 0x3e48bf7b, 0x3ec4bf6d, 0x3f0ebf55
.long 0x00003f80, 0x0000bf80, 0x00003f80, 0x0000bf80, 0xbf35bf35, 0x3f553f0e, 0xbf6dbec4, 0x3f7b3e48
.long 0x3f800000, 0xbf6d3ec4, 0x3f35bf35, 0xbec43f6d, 0xbf353f35, 0x3e48bf7b, 0x3ec43f6d, 0xbf55bf0e
.long 0x0000bf80, 0x3f353f35, 0xbf800000, 0x3f35bf35, 0x3f353f35, 0xbf7b3e48, 0x3ec4bf6d, 0x3f0e3f55
.long 0xbf800000, 0x3ec4bf6d, 0x3f353f35, 0xbf6d3ec4, 0x3f35bf35, 0x3f0e3f55, 0xbf6d3ec4, 0xbe48bf7b
.long 0x00003f80, 0xbf800000, 0x0000bf80, 0x3f800000, 0xbf35bf35, 0x3f0ebf55, 0x3f6d3ec4, 0xbe483f7b
.long 0x3f800000, 0x3ec43f6d, 0xbf353f35, 0xbf6dbec4, 0xbf353f35, 0xbf7bbe48, 0xbec4bf6d, 0x3f0ebf55
.long 0x0000bf80, 0x3f35bf35, 0x3f800000, 0x3f353f35, 0x3f353f35, 0x3e483f7b, 0xbec43f6d, 0xbf553f0e
.long 0xbf800000, 0xbf6dbec4, 0xbf35bf35, 0xbec4bf6d, 0x3f35bf35, 0x3f55bf0e, 0x3f6dbec4, 0x3f7bbe48
.long 0x00003f80, 0x0000bf80, 0x00003f80, 0x0000bf80, 0xbf800000, 0x3f7bbe48, 0xbf6d3ec4, 0x3f55bf0e
.long 0x0000bf80, 0x3ec43f6d, 0xbf35bf35, 0x3f6d3ec4, 0x3f800000, 0xbf553f0e, 0x3ec4bf6d, 0x3e483f7b
.long 0x00003f80, 0xbf35bf35, 0x3f800000, 0xbf353f35, 0xbf800000, 0x3f0ebf55, 0x3ec43f6d, 0xbf7bbe48
.long 0x0000bf80, 0x3f6d3ec4, 0xbf353f35, 0xbec4bf6d, 0x3f800000, 0xbe483f7b, 0xbf6dbec4, 0x3f0ebf55
.long 0x00003f80, 0xbf800000, 0x0000bf80, 0x3f800000, 0xbf800000, 0xbe48bf7b, 0x3f6dbec4, 0x3f0e3f55
.long 0x0000bf80, 0x3f6dbec4, 0x3f353f35, 0xbec43f6d, 0x3f800000, 0x3f0e3f55, 0xbec43f6d, 0xbf7b3e48
.long 0x00003f80, 0xbf353f35, 0xbf800000, 0xbf35bf35, 0xbf800000, 0xbf55bf0e, 0xbec4bf6d, 0x3e48bf7b
.long 0x0000bf80, 0x3ec4bf6d, 0x3f35bf35, 0x3f6dbec4, 0x3f800000, 0x3f7b3e48, 0x3f6d3ec4, 0x3f553f0e
.long 0x00003f80, 0x0000bf80, 0x00003f80, 0x0000bf80, 0xbf353f35, 0x3f0ebf55, 0xbec43f6d, 0x3e48bf7b
.long 0xbf800000, 0x3f6dbec4, 0xbf353f35, 0x3ec4bf6d, 0xbf35bf35, 0x3f7b3e48, 0xbf6d3ec4, 0x3f0ebf55
.long 0x0000bf80, 0x3f353f35, 0xbf800000, 0x3f35bf35, 0x3f35bf35, 0x3e483f7b, 0xbf6dbec4, 0x3f55bf0e
.long 0x3f800000, 0xbec43f6d, 0xbf35bf35, 0x3f6dbec4, 0x3f353f35, 0xbf553f0e, 0xbec4bf6d, 0x3f7bbe48
.long 0x00003f80, 0xbf800000, 0x0000bf80, 0x3f800000, 0xbf353f35, 0xbf55bf0e, 0x3ec4bf6d, 0x3f7b3e48
.long 0xbf800000, 0xbec4bf6d, 0x3f35bf35, 0x3f6d3ec4, 0xbf35bf35, 0x3e48bf7b, 0x3f6dbec4, 0x3f553f0e
.long 0x0000bf80, 0x3f35bf35, 0x3f800000, 0x3f353f35, 0x3f35bf35, 0x3f7bbe48, 0x3f6d3ec4, 0x3f0e3f55
.long 0x3f800000, 0x3f6d3ec4, 0x3f353f35, 0x3ec43f6d, 0x3f353f35, 0x3f0e3f55, 0x3ec43f6d, 0x3e483f7b
.long 0x3f800000, 0x00000000, 0x3f800000, 0x00000000, 0x3f800000, 0x00000000, 0x3f800000, 0x00000000
.long 0x3f800000, 0x00000000, 0x3f7b14be, 0x3e47c5c2, 0x00000000, 0x3f800000, 0xbe47c5c2, 0x3f7b14be
.long 0x3f800000, 0x00000000, 0x3f7ffb11, 0x3c490e90, 0x3f7ec46d, 0x3dc8bd36, 0x3f7e70b0, 0x3de1bc2e
.long 0x3f800000, 0x00000000, 0x3f7a7302, 0x3e541501, 0xbdc8bd36, 0x3f7ec46d, 0xbe9aa086, 0x3f740bdd
.long 0x3f800000, 0x00000000, 0x3f7fec43, 0x3cc90ab0, 0x3f7b14be, 0x3e47c5c2, 0x3f79c79d, 0x3e605c13
.long 0x3f800000, 0x00000000, 0x3f79c79d, 0x3e605c13, 0xbe47c5c2, 0x3f7b14be, 0xbecf7bca, 0x3f6a09a7
.long 0x3f800000, 0x00000000, 0x3f7fd397, 0x3d16c32c, 0x3f74fa0b, 0x3e94a031, 0x3f721352, 0x3ea68f12
.long 0x3f800000, 0x00000000, 0x3f791298, 0x3e6c9a7f, 0xbe94a031, 0x3f74fa0b, 0xbf00e7e4, 0x3f5d2d53
.long 0x3f800000, 0x00000000, 0x3f7fb10f, 0x3d48fb30, 0x3f6c835e, 0x3ec3ef15, 0x3f676bd8, 0x3edae880
.long 0x3f800000, 0x00000000, 0x3f7853f8, 0x3e78cfcc, 0xbec3ef15, 0x3f6c835e, 0xbf187fc0, 0x3f4d9f02
.long 0x3f800000, 0x00000000, 0x3f7f84ab, 0x3d7b2b74, 0x3f61c598, 0x3ef15aea, 0x3f59f26a, 0x3f064b82
.long 0x3f800000, 0x00000000, 0x3f778bc5, 0x3e827dc0, 0xbef15aea, 0x3f61c598, 0xbf2e3bde, 0x3f3b8f3b
.long 0x3f800000, 0x00000000, 0x3f7f4e6d, 0x3d96a905, 0x3f54db31, 0x3f0e39da, 0x3f49d112, 0x3f1d7fd1
.long 0x3f800000, 0x00000000, 0x3f76ba07, 0x3e888e93, 0xbf0e39da, 0x3f54db31, 0xbf41d870, 0x3f273656
.long 0x3f800000, 0x00000000, 0x3f7f0e58, 0x3dafb680, 0x3f45e403, 0x3f226799, 0x3f373a23, 0x3f32c8c9
.long 0x3f800000, 0x00000000, 0x3f75dec6, 0x3e8e9a22, 0xbf226799, 0x3f45e403, 0xbf531849, 0x3f10d3cd
.long 0x3f800000, 0x00000000, 0x3f7ec46d, 0x3dc8bd36, 0x3f3504f3, 0x3f3504f3, 0x3f226799, 0x3f45e403
.long 0x3f800000, 0x00000000, 0x3f74fa0b, 0x3e94a031, 0xbf3504f3, 0x3f3504f3, 0xbf61c598, 0x3ef15aea
.long 0x3f800000, 0x00000000, 0x3f7e70b0, 0x3de1bc2e, 0x3f226799, 0x3f45e403, 0x3f0b9a6b, 0x3f5695e5
.long 0x3f800000, 0x00000000, 0x3f740bdd, 0x3e9aa086, 0xbf45e403, 0x3f226799, 0xbf6db293, 0x3ebe1d4a
.long 0x3f800000, 0x00000000, 0x3f7e1324, 0x3dfab273, 0x3f0e39da, 0x3f54db31, 0x3ee63375, 0x3f64aa59
.long 0x3f800000, 0x00000000, 0x3f731447, 0x3ea09ae5, 0xbf54db31, 0x3f0e39da, 0xbf76ba07, 0x3e888e93
.long 0x3f800000, 0x00000000, 0x3f7dabcc, 0x3e09cf86, 0x3ef15aea, 0x3f61c598, 0x3eb263ef, 0x3f6ff573
.long 0x3f800000, 0x00000000, 0x3f721352, 0x3ea68f12, 0xbf61c598, 0x3ef15aea, 0xbf7cbfc9, 0x3e22abb6
.long 0x3f800000, 0x00000000, 0x3f7d3aac, 0x3e164083, 0x3ec3ef15, 0x3f6c835e, 0x3e78cfcc, 0x3f7853f8
.long 0x3f800000, 0x00000000, 0x3f710908, 0x3eac7cd4, 0xbf6c835e, 0x3ec3ef15, 0xbf7fb10f, 0x3d48fb30
.long 0x3f800000, 0x00000000, 0x3f7cbfc9, 0x3e22abb6, 0x3e94a031, 0x3f74fa0b, 0x3e09cf86, 0x3f7dabcc
.long 0x3f800000, 0x00000000, 0x3f6ff573, 0x3eb263ef, 0xbf74fa0b, 0x3e94a031, 0xbf7f84ab, 0xbd7b2b74
.long 0x3f800000, 0x00000000, 0x3f7c3b28, 0x3e2f10a2, 0x3e47c5c2, 0x3f7b14be, 0x3cc90ab0, 0x3f7fec43
.long 0x3f800000, 0x00000000, 0x3f6ed89e, 0x3eb8442a, 0xbf7b14be, 0x3e47c5c2, 0xbf7c3b28, 0xbe2f10a2
.long 0x3f800000, 0x00000000, 0x3f7baccd, 0x3e3b6ecf, 0x3dc8bd36, 0x3f7ec46d, 0xbdafb680, 0x3f7f0e58
.long 0x3f800000, 0x00000000, 0x3f6db293, 0x3ebe1d4a, 0xbf7ec46d, 0x3dc8bd36, 0xbf75dec6, 0xbe8e9a22
.long 0x3f800000, 0x00000000, 0x3f800000, 0x00000000, 0x3f800000, 0x00000000, 0x3f800000, 0x00000000
.long 0x3f6c835e, 0x3ec3ef15, 0x3f54db31, 0x3f0e39da, 0xbec3ef15, 0x3f6c835e, 0xbf0e39da, 0x3f54db31
.long 0x3f7fec43, 0x3cc90ab0, 0x3f7fd397, 0x3d16c32c, 0x3f7e1324, 0x3dfab273, 0x3f7dabcc, 0x3e09cf86
.long 0x3f6a09a7, 0x3ecf7bca, 0x3f4f7a1f, 0x3f15f6d9, 0xbefc5d27, 0x3f5ebe05, 0xbf299415, 0x3f3fc767
.long 0x3f7fb10f, 0x3d48fb30, 0x3f7f4e6d, 0x3d96a905, 0x3f7853f8, 0x3e78cfcc, 0x3f76ba07, 0x3e888e93
.long 0x3f676bd8, 0x3edae880, 0x3f49d112, 0x3f1d7fd1, 0xbf187fc0, 0x3f4d9f02, 0xbf41d870, 0x3f273656
.long 0x3f7f4e6d, 0x3d96a905, 0x3f7e70b0, 0x3de1bc2e, 0x3f6ed89e, 0x3eb8442a, 0x3f6b4b0c, 0x3ec9b953
.long 0x3f64aa59, 0x3ee63375, 0x3f43e200, 0x3f24d225, 0xbf3085bb, 0x3f396842, 0xbf5695e5, 0x3f0b9a6b
.long 0x3f7ec46d, 0x3dc8bd36, 0x3f7d3aac, 0x3e164083, 0x3f61c598, 0x3ef15aea, 0x3f5b941a, 0x3f039c3d
.long 0x3f61c598, 0x3ef15aea, 0x3f3daef9, 0x3f2beb4a, 0xbf45e403, 0x3f226799, 0xbf676bd8, 0x3edae880
.long 0x3f7e1324, 0x3dfab273, 0x3f7baccd, 0x3e3b6ecf, 0x3f514d3d, 0x3f13682a, 0x3f47de65, 0x3f1ff6cb
.long 0x3f5ebe05, 0x3efc5d27, 0x3f373a23, 0x3f32c8c9, 0xbf584853, 0x3f08f59b, 0xbf740bdd, 0x3e9aa086
.long 0x3f7d3aac, 0x3e164083, 0x3f79c79d, 0x3e605c13, 0x3f3daef9, 0x3f2beb4a, 0x3f3085bb, 0x3f396842
.long 0x3f5b941a, 0x3f039c3d, 0x3f3085bb, 0x3f396842, 0xbf676bd8, 0x3edae880, 0xbf7c3b28, 0x3e2f10a2
.long 0x3f7c3b28, 0x3e2f10a2, 0x3f778bc5, 0x3e827dc0, 0x3f273656, 0x3f41d870, 0x3f15f6d9, 0x3f4f7a1f
.long 0x3f584853, 0x3f08f59b, 0x3f299415, 0x3f3fc767, 0xbf731447, 0x3ea09ae5, 0xbf7fd397, 0x3d16c32c
.long 0x3f7b14be, 0x3e47c5c2, 0x3f74fa0b, 0x3e94a031, 0x3f0e39da, 0x3f54db31, 0x3ef15aea, 0x3f61c598
.long 0x3f54db31, 0x3f0e39da, 0x3f226799, 0x3f45e403, 0xbf7b14be, 0x3e47c5c2, 0xbf7ec46d, 0xbdc8bd36
.long 0x3f79c79d, 0x3e605c13, 0x3f721352, 0x3ea68f12, 0x3ee63375, 0x3f64aa59, 0x3eb263ef, 0x3f6ff573
.long 0x3f514d3d, 0x3f13682a, 0x3f1b02c6, 0x3f4bbbf8, 0xbf7f4e6d, 0x3d96a905, 0xbf791298, 0xbe6c9a7f
.long 0x3f7853f8, 0x3e78cfcc, 0x3f6ed89e, 0x3eb8442a, 0x3eac7cd4, 0x3f710908, 0x3e605c13, 0x3f79c79d
.long 0x3f4d9f02, 0x3f187fc0, 0x3f13682a, 0x3f514d3d, 0xbf7fb10f, 0xbd48fb30, 0xbf6ed89e, 0xbeb8442a
.long 0x3f76ba07, 0x3e888e93, 0x3f6b4b0c, 0x3ec9b953, 0x3e605c13, 0x3f79c79d, 0x3dafb680, 0x3f7f0e58
.long 0x3f49d112, 0x3f1d7fd1, 0x3f0b9a6b, 0x3f5695e5, 0xbf7c3b28, 0xbe2f10a2, 0xbf604621, 0xbef6e0cb
.long 0x3f74fa0b, 0x3e94a031, 0x3f676bd8, 0x3edae880, 0x3dc8bd36, 0x3f7ec46d, 0xbd48fb30, 0x3f7fb10f
.long 0x3f45e403, 0x3f226799, 0x3f039c3d, 0x3f5b941a, 0xbf74fa0b, 0xbe94a031, 0xbf4d9f02, 0xbf187fc0
.long 0x3f731447, 0x3ea09ae5, 0x3f633c5a, 0x3eebcbbb, 0xbcc90ab0, 0x3f7fec43, 0xbe3b6ecf, 0x3f7baccd
.long 0x3f41d870, 0x3f273656, 0x3ef6e0cb, 0x3f604621, 0xbf6a09a7, 0xbecf7bca, 0xbf373a23, 0xbf32c8c9
.long 0x3f710908, 0x3eac7cd4, 0x3f5ebe05, 0x3efc5d27, 0xbe164083, 0x3f7d3aac, 0xbea09ae5, 0x3f731447
.long 0x3f3daef9, 0x3f2beb4a, 0x3ee63375, 0x3f64aa59, 0xbf5b941a, 0xbf039c3d, 0xbf1d7fd1, 0xbf49d112
.long 0x3f6ed89e, 0x3eb8442a, 0x3f59f26a, 0x3f064b82, 0xbe888e93, 0x3f76ba07, 0xbee0924f, 0x3f660f88
.long 0x3f396842, 0x3f3085bb, 0x3ed53641, 0x3f68bf3c, 0xbf49d112, 0xbf1d7fd1, 0xbf00e7e4, 0xbf5d2d53
.long 0x3f800000, 0x00000000, 0x3f800000, 0x00000000, 0x3f800000, 0x00000000, 0x3f800000, 0x00000000
.long 0x3f3504f3, 0x3f3504f3, 0x3f0e39da, 0x3f54db31, 0xbf3504f3, 0x3f3504f3, 0xbf54db31, 0x3f0e39da
.long 0x3f7fb10f, 0x3d48fb30, 0x3f7f84ab, 0x3d7b2b74, 0x3f7d3aac, 0x3e164083, 0x3f7cbfc9, 0x3e22abb6
.long 0x3f2beb4a, 0x3f3daef9, 0x3f00e7e4, 0x3f5d2d53, 0xbf4d9f02, 0x3f187fc0, 0xbf68bf3c, 0x3ed53641
.long 0x3f7ec46d, 0x3dc8bd36, 0x3f7e1324, 0x3dfab273, 0x3f74fa0b, 0x3e94a031, 0x3f731447, 0x3ea09ae5
.long 0x3f226799, 0x3f45e403, 0x3ee63375, 0x3f64aa59, 0xbf61c598, 0x3ef15aea, 0xbf76ba07, 0x3e888e93
.long 0x3f7d3aac, 0x3e164083, 0x3f7baccd, 0x3e3b6ecf, 0x3f676bd8, 0x3edae880, 0x3f633c5a, 0x3eebcbbb
.long 0x3f187fc0, 0x3f4d9f02, 0x3ec9b953, 0x3f6b4b0c, 0xbf710908, 0x3eac7cd4, 0xbf7e70b0, 0x3de1bc2e
.long 0x3f7b14be, 0x3e47c5c2, 0x3f7853f8, 0x3e78cfcc, 0x3f54db31, 0x3f0e39da, 0x3f4d9f02, 0x3f187fc0
.long 0x3f0e39da, 0x3f54db31, 0x3eac7cd4, 0x3f710908, 0xbf7b14be, 0x3e47c5c2, 0xbf7fb10f, 0xbd48fb30
.long 0x3f7853f8, 0x3e78cfcc, 0x3f740bdd, 0x3e9aa086, 0x3f3daef9, 0x3f2beb4a, 0x3f32c8c9, 0x3f373a23
.long 0x3f039c3d, 0x3f5b941a, 0x3e8e9a22, 0x3f75dec6, 0xbf7fb10f, 0x3d48fb30, 0xbf7a7302, 0xbe541501
.long 0x3f74fa0b, 0x3e94a031, 0x3f6ed89e, 0x3eb8442a, 0x3f226799, 0x3f45e403, 0x3f13682a, 0x3f514d3d
.long 0x3ef15aea, 0x3f61c598, 0x3e605c13, 0x3f79c79d, 0xbf7ec46d, 0xbdc8bd36, 0xbf6ed89e, 0xbeb8442a
.long 0x3f710908, 0x3eac7cd4, 0x3f68bf3c, 0x3ed53641, 0x3f039c3d, 0x3f5b941a, 0x3ee0924f, 0x3f660f88
.long 0x3edae880, 0x3f676bd8, 0x3e22abb6, 0x3f7cbfc9, 0xbf7853f8, 0xbe78cfcc, 0xbf5d2d53, 0xbf00e7e4
.long 0x3f6c835e, 0x3ec3ef15, 0x3f61c598, 0x3ef15aea, 0x3ec3ef15, 0x3f6c835e, 0x3e94a031, 0x3f74fa0b
.long 0x3ec3ef15, 0x3f6c835e, 0x3dc8bd36, 0x3f7ec46d, 0xbf6c835e, 0xbec3ef15, 0xbf45e403, 0xbf226799
.long 0x3f676bd8, 0x3edae880, 0x3f59f26a, 0x3f064b82, 0x3e78cfcc, 0x3f7853f8, 0x3e09cf86, 0x3f7dabcc
.long 0x3eac7cd4, 0x3f710908, 0x3d16c32c, 0x3f7fd397, 0xbf5b941a, 0xbf039c3d, 0xbf299415, 0xbf3fc767
.long 0x3f61c598, 0x3ef15aea, 0x3f514d3d, 0x3f13682a, 0x3dc8bd36, 0x3f7ec46d, 0xbcc90ab0, 0x3f7fec43
.long 0x3e94a031, 0x3f74fa0b, 0xbcc90ab0, 0x3f7fec43, 0xbf45e403, 0xbf226799, 0xbf08f59b, 0xbf584853
.long 0x3f5b941a, 0x3f039c3d, 0x3f47de65, 0x3f1ff6cb, 0xbd48fb30, 0x3f7fb10f, 0xbe3b6ecf, 0x3f7baccd
.long 0x3e78cfcc, 0x3f7853f8, 0xbdafb680, 0x3f7f0e58, 0xbf2beb4a, 0xbf3daef9, 0xbec9b953, 0xbf6b4b0c
.long 0x3f54db31, 0x3f0e39da, 0x3f3daef9, 0x3f2beb4a, 0xbe47c5c2, 0x3f7b14be, 0xbeac7cd4, 0x3f710908
.long 0x3e47c5c2, 0x3f7b14be, 0xbe164083, 0x3f7d3aac, 0xbf0e39da, 0xbf54db31, 0xbe78cfcc, 0xbf7853f8
.long 0x3f4d9f02, 0x3f187fc0, 0x3f32c8c9, 0x3f373a23, 0xbeac7cd4, 0x3f710908, 0xbef6e0cb, 0x3f604621
.long 0x3e164083, 0x3f7d3aac, 0xbe541501, 0x3f7a7302, 0xbedae880, 0xbf676bd8, 0xbdafb680, 0xbf7f0e58
.long 0x3f45e403, 0x3f226799, 0x3f273656, 0x3f41d870, 0xbef15aea, 0x3f61c598, 0xbf1d7fd1, 0x3f49d112
.long 0x3dc8bd36, 0x3f7ec46d, 0xbe888e93, 0x3f76ba07, 0xbe94a031, 0xbf74fa0b, 0x3d96a905, 0xbf7f4e6d
.long 0x3f3daef9, 0x3f2beb4a, 0x3f1b02c6, 0x3f4bbbf8, 0xbf187fc0, 0x3f4d9f02, 0xbf3b8f3b, 0x3f2e3bde
.long 0x3d48fb30, 0x3f7fb10f, 0xbea68f12, 0x3f721352, 0xbe164083, 0xbf7d3aac, 0x3e6c9a7f, 0xbf791298
.long 0x3f800000, 0x00000000, 0x3f800000, 0x00000000, 0x3f800000, 0x00000000, 0x3f800000, 0x00000000
.long 0x3ec3ef15, 0x3f6c835e, 0x3e47c5c2, 0x3f7b14be, 0xbf6c835e, 0x3ec3ef15, 0xbf7b14be, 0x3e47c5c2
.long 0x3f7f4e6d, 0x3d96a905, 0x3f7f0e58, 0x3dafb680, 0x3f7c3b28, 0x3e2f10a2, 0x3f7baccd, 0x3e3b6ecf
.long 0x3ea09ae5, 0x3f731447, 0x3de1bc2e, 0x3f7e70b0, 0xbf79c79d, 0x3e605c13, 0xbf7ffb11, 0x3c490e90
.long 0x3f7d3aac, 0x3e164083, 0x3f7c3b28, 0x3e2f10a2, 0x3f710908, 0x3eac7cd4, 0x3f6ed89e, 0x3eb8442a
.long 0x3e78cfcc, 0x3f7853f8, 0x3cc90ab0, 0x3f7fec43, 0xbf7fb10f, 0x3d48fb30, 0xbf7c3b28, 0xbe2f10a2
.long 0x3f79c79d, 0x3e605c13, 0x3f778bc5, 0x3e827dc0, 0x3f5ebe05, 0x3efc5d27, 0x3f59f26a, 0x3f064b82
.long 0x3e2f10a2, 0x3f7c3b28, 0xbd7b2b74, 0x3f7f84ab, 0xbf7e1324, 0xbdfab273, 0xbf6ff573, 0xbeb263ef
.long 0x3f74fa0b, 0x3e94a031, 0x3f710908, 0x3eac7cd4, 0x3f45e403, 0x3f226799, 0x3f3daef9, 0x3f2beb4a
.long 0x3dc8bd36, 0x3f7ec46d, 0xbe164083, 0x3f7d3aac, 0xbf74fa0b, 0xbe94a031, 0xbf5b941a, 0xbf039c3d
.long 0x3f6ed89e, 0x3eb8442a, 0x3f68bf3c, 0x3ed53641, 0x3f273656, 0x3f41d870, 0x3f1b02c6, 0x3f4bbbf8
.long 0x3cc90ab0, 0x3f7fec43, 0xbe6c9a7f, 0x3f791298, 0xbf64aa59, 0xbee63375, 0xbf3fc767, 0xbf299415
.long 0x3f676bd8, 0x3edae880, 0x3f5ebe05, 0x3efc5d27, 0x3f039c3d, 0x3f5b941a, 0x3ee63375, 0x3f64aa59
.long 0xbd48fb30, 0x3f7fb10f, 0xbea09ae5, 0x3f731447, 0xbf4d9f02, 0xbf187fc0, 0xbf1d7fd1, 0xbf49d112
.long 0x3f5ebe05, 0x3efc5d27, 0x3f531849, 0x3f10d3cd, 0x3eb8442a, 0x3f6ed89e, 0x3e8e9a22, 0x3f75dec6
.long 0xbdfab273, 0x3f7e1324, 0xbec9b953, 0x3f6b4b0c, 0xbf3085bb, 0xbf396842, 0xbeebcbbb, 0xbf633c5a
.long 0x3f54db31, 0x3f0e39da, 0x3f45e403, 0x3f226799, 0x3e47c5c2, 0x3f7b14be, 0x3dc8bd36, 0x3f7ec46d
.long 0xbe47c5c2, 0x3f7b14be, 0xbef15aea, 0x3f61c598, 0xbf0e39da, 0xbf54db31, 0xbe94a031, 0xbf74fa0b
.long 0x3f49d112, 0x3f1d7fd1, 0x3f373a23, 0x3f32c8c9, 0x3cc90ab0, 0x3f7fec43, 0xbdafb680, 0x3f7f0e58
.long 0xbe888e93, 0x3f76ba07, 0xbf0b9a6b, 0x3f5695e5, 0xbecf7bca, 0xbf6a09a7, 0xbde1bc2e, 0xbf7e70b0
.long 0x3f3daef9, 0x3f2beb4a, 0x3f273656, 0x3f41d870, 0xbe164083, 0x3f7d3aac, 0xbe888e93, 0x3f76ba07
.long 0xbeac7cd4, 0x3f710908, 0xbf1d7fd1, 0x3f49d112, 0xbe78cfcc, 0xbf7853f8, 0x3d96a905, 0xbf7f4e6d
.long 0x3f3085bb, 0x3f396842, 0x3f15f6d9, 0x3f4f7a1f, 0xbea09ae5, 0x3f731447, 0xbee0924f, 0x3f660f88
.long 0xbecf7bca, 0x3f6a09a7, 0xbf2e3bde, 0x3f3b8f3b, 0xbd96a905, 0xbf7f4e6d, 0x3e827dc0, 0xbf778bc5
.long 0x3f226799, 0x3f45e403, 0x3f039c3d, 0x3f5b941a, 0xbef15aea, 0x3f61c598, 0xbf187fc0, 0x3f4d9f02
.long 0xbef15aea, 0x3f61c598, 0xbf3daef9, 0x3f2beb4a, 0x3dc8bd36, 0xbf7ec46d, 0x3edae880, 0xbf676bd8
.long 0x3f13682a, 0x3f514d3d, 0x3ee0924f, 0x3f660f88, 0xbf1d7fd1, 0x3f49d112, 0xbf3b8f3b, 0x3f2e3bde
.long 0xbf08f59b, 0x3f584853, 0xbf4bbbf8, 0x3f1b02c6, 0x3e888e93, 0xbf76ba07, 0x3f15f6d9, 0xbf4f7a1f
.long 0x3f039c3d, 0x3f5b941a, 0x3eb8442a, 0x3f6ed89e, 0xbf3daef9, 0x3f2beb4a, 0xbf584853, 0x3f08f59b
.long 0xbf187fc0, 0x3f4d9f02, 0xbf584853, 0x3f08f59b, 0x3edae880, 0xbf676bd8, 0x3f396842, 0xbf3085bb
.long 0x3ee63375, 0x3f64aa59, 0x3e8e9a22, 0x3f75dec6, 0xbf584853, 0x3f08f59b, 0xbf6db293, 0x3ebe1d4a
.long 0xbf273656, 0x3f41d870, 0xbf633c5a, 0x3eebcbbb, 0x3f13682a, 0xbf514d3d, 0x3f5695e5, 0xbf0b9a6b
.size fft_tables, 18432
```
